```python
import torch

def _softmax(x, axis=-1):
    return torch.softmax(x, dim=axis)
def _gelu(x):
    return torch.nn.functional.gelu(x, approximate="tanh")
def _silu(x):
    return torch.nn.functional.silu(x)
def _sigmoid(x):
    return torch.sigmoid(x)
def _layernorm(x, axis=-1, eps=1e-5):
    m = x.mean(dim=axis, keepdim=True)
    v = x.var(dim=axis, keepdim=True, unbiased=False)
    return (x - m) / torch.sqrt(v + eps)
def _scatter_add(tgt, idx, src, axis=0):
    return tgt.clone().index_add_(axis, idx, src)
def _segment_sum(src, seg, n):
    out = torch.zeros((n,) + src.shape[1:], dtype=src.dtype)
    return out.index_add_(0, seg, src)
def _pad(x, pw):
    flat = tuple(v for pair in reversed(pw) for v in pair)
    return torch.nn.functional.pad(x, flat)

kernel_name = 'standalone__softmax_full_mha__prompt'

def setup_inputs():

    _w = (lambda a: (lambda t: t.to(torch.bfloat16) if t.is_floating_point() else t)(torch.as_tensor(a)))
    B, S, D = 1, 2048, 448
    return {
        "x": _w((lambda *s: torch.randn(*s, dtype=torch.bfloat16) * 0.2)(B, S, D)),
        "wqkv": _w((lambda *s: torch.randn(*s, dtype=torch.bfloat16) * 0.2)(D, 3 * D)),
        "wo": _w((lambda *s: torch.randn(*s, dtype=torch.bfloat16) * 0.05)(D, D)),
    }

def reference(x, wqkv, wo):
    B, S, D = x.shape
    H = 16; Dh = D // H
    qkv = (lambda x, *d: x.permute(*d))((x @ wqkv).reshape(B, S, 3, H, Dh), 2, 0, 3, 1, 4)
    q, k, v = qkv[0], qkv[1], qkv[2]
    scale = Dh ** -0.5
    scores = torch.einsum("bhqd,bhkd->bhqk", q, k) * scale
    p = _softmax(scores, axis=-1)
    o = torch.einsum("bhqk,bhkd->bhqd", p, v)
    return (lambda x, *d: x.permute(*d))(o, 0, 2, 1, 3).reshape(B, S, D) @ wo
```

```asm
; @launch grid=(256,1,1) block=(512,1,1) lds=163840
.amdgcn_target "amdgcn-amd-amdhsa--gfx950"
.text
.globl standalone__softmax_full_mha__prompt_kernel
.p2align 8
.type standalone__softmax_full_mha__prompt_kernel,@function
standalone__softmax_full_mha__prompt_kernel:
    s_cmp_ge_u32 s2, 256
    s_cbranch_scc1 L_end
    s_load_dwordx8 s[4:11], s[0:1], 0
    s_load_dwordx4 s[12:15], s[0:1], 32
    v_lshrrev_b32 v1, 6, v0
    v_and_b32 v0, 63, v0
    v_readfirstlane_b32 s53, v1
    s_and_b32 s44, s2, 1
    s_lshl_b32 s44, s44, 3
    s_lshr_b32 s3, s2, 3
    s_and_b32 s45, s3, 7
    s_add_u32 s44, s44, s45
    s_lshr_b32 s3, s3, 3
    s_and_b32 s45, s2, 7
    s_lshr_b32 s45, s45, 1
    s_mul_i32 s45, s45, 4
    s_add_u32 s45, s45, s3
    s_lshr_b32 s3, s44, 3
    s_sub_u32 s54, s44, s3
    s_add_u32 s3, s3, 14
    s_and_b32 s44, s44, 7
    s_cmp_eq_u32 s44, 7
    s_cselect_b32 s44, s3, s54
    s_and_b32 s46, s53, 3
    s_lshl_b32 s47, s45, 2
    s_and_b32 s62, s44, 3
    s_add_u32 s62, s62, s47
    s_add_u32 s47, s47, s46
    s_lshr_b32 s63, s44, 2
    s_cmp_lt_u32 s53, 4
    s_cbranch_scc1 L_compute
    v_lshrrev_b32 v7, 3, v0
    v_mul_u32_u24 v2, 896, v7
    v_and_b32 v6, 7, v0
    v_lshrrev_b32 v4, 4, v0
    v_xor_b32 v3, v6, v4
    v_lshl_add_u32 v2, v3, 4, v2
    v_xor_b32 v3, 64, v2
    v_add_u32 v3, 6144, v3
    v_and_b32 v4, 1, v4
    v_lshlrev_b32 v4, 2, v4
    v_xor_b32 v6, v6, v4
    v_mul_u32_u24 v7, 2688, v7
    v_lshl_add_u32 v6, v6, 4, v7
    v_add_u32 v7, 20480, v6
    s_lshl3_add_u32 s49, s45, s46
    s_mul_i32 s49, s49, 14336
    s_mul_i32 s57, s46, 43008
    s_lshl_b32 s50, s44, 7
    s_add_u32 s50, s50, s57
    s_add_u32 s50, s50, 896
    s_mov_b32 s58, 57344
    s_cmp_lt_u32 s44, 14
    s_cbranch_scc1 L_nspare
    s_add_u32 s49, s49, 57344
    s_mov_b32 s58, -57344
    s_and_b32 s3, s44, 1
    s_mul_i32 s3, s3, 3
    s_and_b32 s50, s45, 3
    s_add_u32 s50, s50, s3
    s_lshl_b32 s50, s50, 7
    s_add_u32 s50, s50, s57
L_nspare:
    s_lshl_b32 s52, s46, 11
    s_lshl1_add_u32 s3, s45, s44
    s_mul_i32 s53, s3, 37
    s_lshr_b32 s53, s53, 8
    s_mul_i32 s53, s53, 7
    s_sub_u32 s48, s3, s53
    s_mov_b32 s18, 1835008
    s_mov_b32 s19, 0x20000
    s_mov_b32 s22, 1204224
    s_mov_b32 s23, 0x20000
    s_waitcnt lgkmcnt(0)
    s_load_dword s61, s[14:15], 65280
    s_mov_b32 s16, s4
    s_and_b32 s17, s5, 0xffff
    s_mov_b32 s20, s6
    s_and_b32 s21, s7, 0xffff
    s_mov_b32 s51, s48
    s_mul_i32 s54, s48, 172032
    s_add_u32 m0, s52, 57344
    s_add_u32 s54, s54, s50
    buffer_load_dwordx4 v6, s[20:23], s54 offen lds
    buffer_load_dwordx4 v7, s[20:23], s54 offen offset:1024 lds
    s_lshl_b32 s53, s48, 7
    s_add_u32 m0, s52, 0
    s_add_u32 s53, s53, s49
    buffer_load_dwordx4 v2, s[16:19], s53 offen lds
    buffer_load_dwordx4 v3, s[16:19], s53 offen offset:1024 lds
    s_add_u32 s48, s48, 1
    s_cmp_eq_u32 s48, 7
    s_cselect_b32 s48, 0, s48
    s_mul_i32 s54, s48, 172032
    s_add_u32 m0, s52, 65536
    s_add_u32 s54, s54, s50
    buffer_load_dwordx4 v6, s[20:23], s54 offen lds
    buffer_load_dwordx4 v7, s[20:23], s54 offen offset:1024 lds
    s_lshl_b32 s53, s48, 7
    s_add_u32 m0, s52, 8192
    s_add_u32 s53, s53, s49
    buffer_load_dwordx4 v2, s[16:19], s53 offen lds
    buffer_load_dwordx4 v3, s[16:19], s53 offen offset:1024 lds
    s_add_u32 s48, s48, 1
    s_cmp_eq_u32 s48, 7
    s_cselect_b32 s48, 0, s48
    s_mul_i32 s54, s48, 172032
    s_add_u32 m0, s52, 73728
    s_add_u32 s54, s54, s50
    buffer_load_dwordx4 v6, s[20:23], s54 offen lds
    buffer_load_dwordx4 v7, s[20:23], s54 offen offset:1024 lds
    s_lshl_b32 s53, s48, 7
    s_add_u32 m0, s52, 16384
    s_add_u32 s53, s53, s49
    buffer_load_dwordx4 v2, s[16:19], s53 offen lds
    buffer_load_dwordx4 v3, s[16:19], s53 offen offset:1024 lds
    s_add_u32 s48, s48, 1
    s_cmp_eq_u32 s48, 7
    s_cselect_b32 s48, 0, s48
    s_mov_b32 s36, s14
    s_and_b32 s37, s15, 0xffff
    s_mov_b32 s38, 12582912
    s_mov_b32 s39, 0x20000
    s_mov_b32 s24, s8
    s_and_b32 s25, s9, 0xffff
    s_mov_b32 s26, 401408
    s_mov_b32 s27, 0x20000
    s_mov_b32 s40, s6
    s_and_b32 s41, s7, 0xffff
    s_mov_b32 s42, 1204224
    s_mov_b32 s43, 0x20000
    v_lshlrev_b32 v1, 4, v0
    v_and_b32 v15, 3, v0
    v_lshrrev_b32 v8, 2, v0
    v_mul_u32_u24 v8, 2688, v8
    v_lshl_add_u32 v8, v15, 4, v8
    s_mul_i32 s3, s44, 56
    s_and_b32 s3, s3, 0xfffffff0
    s_add_u32 s57, s57, s3
    s_lshr_b32 s56, s52, 1
    v_mov_b32 v9, 0
    s_mul_i32 s4, s44, 56
    s_and_b32 s5, s4, 0xfffffff0
    v_mov_b32 v16, s5
    s_add_u32 s5, s5, 62
    v_writelane_b32 v16, s5, 1
    s_add_u32 s5, s4, 896
    v_writelane_b32 v16, s5, 2
    s_add_u32 s5, s4, 950
    v_writelane_b32 v16, s5, 3
    v_lshrrev_b32 v16, 6, v16
    v_lshlrev_b32 v16, 12, v16
    s_and_b32 s3, s44, 3
    s_lshl2_add_u32 s3, s3, s46
    s_lshl_b32 s3, s3, 8
    s_add_u32 s3, s3, 5242880
    v_add_u32 v11, s3, v16
    s_lshl_b32 s3, s46, 12
    s_sub_u32 s3, 159744, s3
    v_mov_b32 v12, s3
    ds_write_b32 v12, v9
    s_lshr_b32 s3, s45, 2
    s_lshl1_add_u32 s3, s45, s3
    s_and_b32 s64, s3, 7
    s_mul_i32 s54, s48, 172032
    s_add_u32 m0, s52, 81920
    s_add_u32 s54, s54, s50
    buffer_load_dwordx4 v6, s[20:23], s54 offen lds
    buffer_load_dwordx4 v7, s[20:23], s54 offen offset:1024 lds
    s_lshl_b32 s53, s48, 7
    s_add_u32 m0, s52, 24576
    s_add_u32 s53, s53, s49
    buffer_load_dwordx4 v2, s[16:19], s53 offen lds
    buffer_load_dwordx4 v3, s[16:19], s53 offen offset:1024 lds
    s_add_u32 s48, s48, 1
    s_cmp_eq_u32 s48, 7
    s_cselect_b32 s48, 0, s48
    s_waitcnt vmcnt(12)
    s_barrier
    s_mul_i32 s54, s48, 172032
    s_add_u32 m0, s52, 90112
    s_add_u32 s54, s54, s50
    buffer_load_dwordx4 v6, s[20:23], s54 offen lds
    buffer_load_dwordx4 v7, s[20:23], s54 offen offset:1024 lds
    s_lshl_b32 s53, s48, 7
    s_add_u32 m0, s52, 32768
    s_add_u32 s53, s53, s49
    buffer_load_dwordx4 v2, s[16:19], s53 offen lds
    buffer_load_dwordx4 v3, s[16:19], s53 offen offset:1024 lds
    s_add_u32 s48, s48, 1
    s_cmp_eq_u32 s48, 7
    s_cselect_b32 s48, 0, s48
    s_waitcnt vmcnt(12)
    s_barrier
    s_mul_i32 s54, s48, 172032
    s_add_u32 m0, s52, 98304
    s_add_u32 s54, s54, s50
    buffer_load_dwordx4 v6, s[20:23], s54 offen lds
    buffer_load_dwordx4 v7, s[20:23], s54 offen offset:1024 lds
    s_lshl_b32 s53, s48, 7
    s_add_u32 m0, s52, 40960
    s_add_u32 s53, s53, s49
    buffer_load_dwordx4 v2, s[16:19], s53 offen lds
    buffer_load_dwordx4 v3, s[16:19], s53 offen offset:1024 lds
    s_add_u32 s48, s48, 1
    s_cmp_eq_u32 s48, 7
    s_cselect_b32 s48, 0, s48
    s_waitcnt vmcnt(12)
    s_barrier
    s_mul_i32 s54, s48, 172032
    s_add_u32 m0, s52, 106496
    s_add_u32 s54, s54, s50
    buffer_load_dwordx4 v6, s[20:23], s54 offen lds
    buffer_load_dwordx4 v7, s[20:23], s54 offen offset:1024 lds
    s_lshl_b32 s53, s48, 7
    s_add_u32 m0, s52, 49152
    s_add_u32 s53, s53, s49
    buffer_load_dwordx4 v2, s[16:19], s53 offen lds
    buffer_load_dwordx4 v3, s[16:19], s53 offen offset:1024 lds
    s_add_u32 s48, s48, 1
    s_cmp_eq_u32 s48, 7
    s_cselect_b32 s48, 0, s48
    s_waitcnt vmcnt(12)
    s_barrier
    s_add_u32 s49, s49, s58
    s_lshl_b32 s53, s48, 7
    s_add_u32 m0, s52, 57344
    s_add_u32 s53, s53, s49
    buffer_load_dwordx4 v2, s[16:19], s53 offen lds
    buffer_load_dwordx4 v3, s[16:19], s53 offen offset:1024 lds
    s_add_u32 s48, s48, 1
    s_cmp_eq_u32 s48, 7
    s_cselect_b32 s48, 0, s48
    s_lshl_b32 s53, s48, 7
    s_add_u32 m0, s52, 65536
    s_add_u32 s53, s53, s49
    buffer_load_dwordx4 v2, s[16:19], s53 offen lds
    buffer_load_dwordx4 v3, s[16:19], s53 offen offset:1024 lds
    s_add_u32 s48, s48, 1
    s_cmp_eq_u32 s48, 7
    s_cselect_b32 s48, 0, s48
    s_waitcnt vmcnt(12)
    s_barrier
    s_lshl_b32 s53, s48, 7
    s_add_u32 m0, s52, 73728
    s_add_u32 s53, s53, s49
    buffer_load_dwordx4 v2, s[16:19], s53 offen lds
    buffer_load_dwordx4 v3, s[16:19], s53 offen offset:1024 lds
    s_add_u32 s48, s48, 1
    s_cmp_eq_u32 s48, 7
    s_cselect_b32 s48, 0, s48
    s_lshl_b32 s53, s48, 7
    s_add_u32 m0, s52, 81920
    s_add_u32 s53, s53, s49
    buffer_load_dwordx4 v2, s[16:19], s53 offen lds
    buffer_load_dwordx4 v3, s[16:19], s53 offen offset:1024 lds
    s_add_u32 s48, s48, 1
    s_cmp_eq_u32 s48, 7
    s_cselect_b32 s48, 0, s48
    s_waitcnt vmcnt(12)
    s_barrier
    s_lshl_b32 s53, s48, 7
    s_add_u32 m0, s52, 90112
    s_add_u32 s53, s53, s49
    buffer_load_dwordx4 v2, s[16:19], s53 offen lds
    buffer_load_dwordx4 v3, s[16:19], s53 offen offset:1024 lds
    s_add_u32 s48, s48, 1
    s_cmp_eq_u32 s48, 7
    s_cselect_b32 s48, 0, s48
    s_waitcnt lgkmcnt(0)
    s_waitcnt vmcnt(10)
    s_barrier
    s_lshl_b32 s53, s48, 7
    s_add_u32 m0, s52, 98304
    s_add_u32 s53, s53, s49
    buffer_load_dwordx4 v2, s[16:19], s53 offen lds
    buffer_load_dwordx4 v3, s[16:19], s53 offen offset:1024 lds
    s_add_u32 s48, s48, 1
    s_cmp_eq_u32 s48, 7
    s_cselect_b32 s48, 0, s48
    s_waitcnt vmcnt(8)
    s_barrier
    s_lshl_b32 s53, s48, 7
    s_add_u32 m0, s52, 106496
    s_add_u32 s53, s53, s49
    buffer_load_dwordx4 v2, s[16:19], s53 offen lds
    buffer_load_dwordx4 v3, s[16:19], s53 offen offset:1024 lds
    s_add_u32 s48, s48, 1
    s_cmp_eq_u32 s48, 7
    s_cselect_b32 s48, 0, s48
    s_mul_i32 s54, s51, 172032
    s_add_u32 m0, s56, 114688
    s_add_u32 s54, s54, s57
    buffer_load_dwordx4 v8, s[40:43], s54 offen lds
    s_add_u32 s51, s51, 1
    s_cmp_eq_u32 s51, 7
    s_cselect_b32 s51, 0, s51
    s_mul_i32 s54, s51, 172032
    s_add_u32 m0, s56, 118784
    s_add_u32 s54, s54, s57
    buffer_load_dwordx4 v8, s[40:43], s54 offen lds
    s_add_u32 s51, s51, 1
    s_cmp_eq_u32 s51, 7
    s_cselect_b32 s51, 0, s51
    s_waitcnt vmcnt(8)
    s_barrier
    s_mul_i32 s54, s51, 172032
    s_add_u32 m0, s56, 122880
    s_add_u32 s54, s54, s57
    buffer_load_dwordx4 v8, s[40:43], s54 offen lds
    s_add_u32 s51, s51, 1
    s_cmp_eq_u32 s51, 7
    s_cselect_b32 s51, 0, s51
    s_mul_i32 s54, s51, 172032
    s_add_u32 m0, s56, 126976
    s_add_u32 s54, s54, s57
    buffer_load_dwordx4 v8, s[40:43], s54 offen lds
    s_add_u32 s51, s51, 1
    s_cmp_eq_u32 s51, 7
    s_cselect_b32 s51, 0, s51
    s_mul_i32 s54, s51, 172032
    s_add_u32 m0, s56, 131072
    s_add_u32 s54, s54, s57
    buffer_load_dwordx4 v8, s[40:43], s54 offen lds
    s_add_u32 s51, s51, 1
    s_cmp_eq_u32 s51, 7
    s_cselect_b32 s51, 0, s51
    s_waitcnt vmcnt(7)
    s_barrier
    s_mul_i32 s54, s51, 172032
    s_add_u32 m0, s56, 135168
    s_add_u32 s54, s54, s57
    buffer_load_dwordx4 v8, s[40:43], s54 offen lds
    s_add_u32 s51, s51, 1
    s_cmp_eq_u32 s51, 7
    s_cselect_b32 s51, 0, s51
    s_mul_i32 s54, s51, 172032
    s_add_u32 m0, s56, 139264
    s_add_u32 s54, s54, s57
    buffer_load_dwordx4 v8, s[40:43], s54 offen lds
    s_add_u32 s51, s51, 1
    s_cmp_eq_u32 s51, 7
    s_cselect_b32 s51, 0, s51
    s_waitcnt vmcnt(5)
    s_barrier
    s_waitcnt lgkmcnt(0)
    s_xor_b32 s61, s61, 0x5ac3a53c
    s_mov_b64 exec, 15
    v_mov_b32 v252, 0
    v_mov_b32 v253, 0
    buffer_atomic_or_x2 v[252:253], v11, s[36:39], 0 offen offset:0 sc0 sc1
    s_mov_b64 exec, -1
    s_waitcnt vmcnt(4)
    s_barrier
    s_waitcnt vmcnt(2)
    s_barrier
    s_waitcnt vmcnt(1)
    s_barrier
    s_mov_b32 s59, 0x100000
    s_mov_b32 s56, 0
    s_branch L_hpoll_in
L_hpoll:
    s_sub_u32 s59, s59, 1
    s_cbranch_scc1 L_hpoll_giveup
    s_mov_b64 exec, 15
    v_mov_b32 v252, 0
    v_mov_b32 v253, 0
    buffer_atomic_or_x2 v[252:253], v11, s[36:39], 0 offen offset:0 sc0 sc1
    s_mov_b64 exec, -1
L_hpoll_in:
    s_waitcnt vmcnt(0)
    v_cmp_eq_u32 vcc, s61, v253
    s_nop 1
    v_cndmask_b32 v252, 0, v252, vcc
    s_nop 0
    v_readlane_b32 s4, v252, 0
    v_readlane_b32 s5, v252, 1
    v_readlane_b32 s6, v252, 2
    v_readlane_b32 s7, v252, 3
    s_and_b32 s4, s4, s5
    s_and_b32 s6, s6, s7
    s_and_b32 s4, s4, s6
    s_cmp_eq_u32 s4, 0xffff
    s_cselect_b32 s4, 0x7ffff, s4
    v_mov_b32 v15, s4
    ds_write_b32 v12, v15
    s_cmp_eq_u32 s4, 0x7ffff
    s_cbranch_scc1 L_hpoll_done
    s_bcnt1_i32_b32 s5, s4
    s_cmp_lt_u32 s5, 2
    s_cselect_b32 s5, 1, s56
    s_cmp_lg_u32 s5, 0
    s_cbranch_scc1 L_hnob8
    s_barrier
    s_mov_b32 s56, 1
L_hnob8:
    s_branch L_hpoll
L_hpoll_giveup:
    v_mov_b32 v15, 0x7ffff
    ds_write_b32 v12, v15
L_hpoll_done:
    s_cmp_lg_u32 s56, 0
    s_cbranch_scc1 L_hb8done
    s_barrier
L_hb8done:
    s_or_b32 s3, s2, s46
    s_cmp_lg_u32 s3, 0
    s_cbranch_scc1 L_noep
    v_lshrrev_b32 v16, 2, v0
    v_and_b32 v17, 3, v0
    v_lshl_add_u32 v16, v16, 4, v17
    v_lshlrev_b32 v16, 8, v16
    v_add_u32 v16, 5242880, v16
    s_mov_b32 s59, 0x100000
    s_mov_b64 exec, -1
    s_branch L_pollep0_in
L_pollep0:
L_pollep0_in:
    v_mov_b32 v252, 0
    v_mov_b32 v253, 0
    buffer_atomic_or_x2 v[252:253], v16, s[36:39], 0 offen offset:0 sc0 sc1
    s_sub_u32 s59, s59, 1
    s_cbranch_scc1 L_pollep0_done
    s_waitcnt vmcnt(0)
    v_cmp_eq_u32 vcc, s61, v253
    s_nop 1
    v_cndmask_b32 v252, 0, v252, vcc
    v_and_b32 v252, 0xff, v252
    v_cmp_ne_u32 vcc, 0xff, v252
    s_cbranch_vccnz L_pollep0
L_pollep0_done:
    s_mov_b64 exec, -1
    v_add_u32 v16, 65536, v16
    s_mov_b32 s59, 0x100000
    s_mov_b64 exec, -1
    s_branch L_pollep1_in
L_pollep1:
L_pollep1_in:
    v_mov_b32 v252, 0
    v_mov_b32 v253, 0
    buffer_atomic_or_x2 v[252:253], v16, s[36:39], 0 offen offset:0 sc0 sc1
    s_sub_u32 s59, s59, 1
    s_cbranch_scc1 L_pollep1_done
    s_waitcnt vmcnt(0)
    v_cmp_eq_u32 vcc, s61, v253
    s_nop 1
    v_cndmask_b32 v252, 0, v252, vcc
    v_and_b32 v252, 0xff, v252
    v_cmp_ne_u32 vcc, 0xff, v252
    s_cbranch_vccnz L_pollep1
L_pollep1_done:
    s_mov_b64 exec, -1
    s_xor_b32 s3, s61, 0x5ac3a53c
    s_add_u32 s3, s3, 0x9e3779b9
    v_mov_b32 v17, s3
    v_mov_b32 v16, 65280
    s_mov_b64 exec, 1
    buffer_store_dword v17, v16, s[36:39], 0 offen sc1
    s_mov_b64 exec, -1
    s_nop 0
L_noep:
    v_lshrrev_b32 v16, 4, v0
    v_mul_u32_u24 v13, 896, v16
    v_lshlrev_b32 v16, 2, v16
    v_and_b32 v17, 15, v0
    v_xor_b32 v16, v16, v17
    v_lshl_add_u32 v13, v16, 4, v13
    s_cmp_eq_u32 s63, 3
    s_cselect_b32 s3, 8, 0
    v_and_b32 v16, s3, v16
    v_lshl_add_u32 v13, v16, 20, v13
    s_lshl_b32 s58, s63, 8
    s_mul_i32 s3, s46, 100352
    s_add_u32 s58, s58, s3
    s_mul_i32 s52, s46, 28672
    s_and_b32 s48, s62, 15
    s_mul_i32 s48, s48, 7
    s_lshr_b32 s48, s48, 2
    s_mov_b32 s56, 28
L_wo:
    s_lshl_b32 s3, s48, 10
    s_add_u32 m0, s3, s52
    s_mul_i32 s3, s48, 3584
    s_add_u32 s3, s3, s58
    buffer_load_dwordx4 v13, s[24:27], s3 offen lds
    s_waitcnt vmcnt(2)
    s_add_u32 s48, s48, 1
    s_cmp_eq_u32 s48, 28
    s_cselect_b32 s48, 0, s48
    s_sub_u32 s56, s56, 1
    s_cmp_lg_u32 s56, 0
    s_cbranch_scc1 L_wo
    s_lshl_b32 s3, s62, 8
    s_add_u32 s3, s3, 5373952
    v_mov_b32 v11, s3
    s_lshl_b32 s4, s46, 2
    s_lshl_b32 s4, 15, s4
    s_lshl_b32 s3, s62, 2
    s_add_u32 s3, s3, s46
    s_lshl_b32 s3, s3, 13
    s_add_u32 s3, s3, 6291456
    s_add_u32 s53, s3, 4096
    s_lshl_b32 s54, s46, 13
    s_add_u32 s54, s54, 114688
    v_add_u32 v12, s54, v1
    s_waitcnt vmcnt(0) lgkmcnt(0)
    s_barrier
    s_mov_b32 s59, 0x100000
    s_mov_b64 exec, 1
    s_branch L_poll2_in
L_poll2:
L_poll2_in:
    v_mov_b32 v252, 0
    v_mov_b32 v253, 0
    buffer_atomic_or_x2 v[252:253], v11, s[36:39], 0 offen offset:0 sc0 sc1
    s_sub_u32 s59, s59, 1
    s_cbranch_scc1 L_poll2_done
    s_waitcnt vmcnt(0)
    v_cmp_eq_u32 vcc, s61, v253
    s_nop 1
    v_cndmask_b32 v252, 0, v252, vcc
    v_and_b32 v252, s4, v252
    v_cmp_ne_u32 vcc, s4, v252
    s_cbranch_vccnz L_poll2
L_poll2_done:
    s_mov_b64 exec, -1
    buffer_load_dwordx4 v[32:35], v1, s[36:39], s3 offen offset:0 sc1
    buffer_load_dwordx4 v[36:39], v1, s[36:39], s3 offen offset:1024 sc1
    buffer_load_dwordx4 v[40:43], v1, s[36:39], s3 offen offset:2048 sc1
    buffer_load_dwordx4 v[44:47], v1, s[36:39], s3 offen offset:3072 sc1
    buffer_load_dwordx4 v[48:51], v1, s[36:39], s53 offen offset:0 sc1
    buffer_load_dwordx4 v[52:55], v1, s[36:39], s53 offen offset:1024 sc1
    buffer_load_dwordx4 v[56:59], v1, s[36:39], s53 offen offset:2048 sc1
    buffer_load_dwordx4 v[60:63], v1, s[36:39], s53 offen offset:3072 sc1
    s_barrier
    s_waitcnt vmcnt(7)
    ds_write_b128 v12, v[32:35] offset:0
    s_waitcnt vmcnt(6)
    ds_write_b128 v12, v[36:39] offset:1024
    s_waitcnt vmcnt(5)
    ds_write_b128 v12, v[40:43] offset:2048
    s_waitcnt vmcnt(4)
    ds_write_b128 v12, v[44:47] offset:3072
    s_waitcnt vmcnt(3)
    ds_write_b128 v12, v[48:51] offset:4096
    s_waitcnt vmcnt(2)
    ds_write_b128 v12, v[52:55] offset:5120
    s_waitcnt vmcnt(1)
    ds_write_b128 v12, v[56:59] offset:6144
    s_waitcnt vmcnt(0)
    ds_write_b128 v12, v[60:63] offset:7168
    s_waitcnt lgkmcnt(0)
    s_barrier
    s_endpgm
L_compute:
    s_waitcnt lgkmcnt(0)
    s_load_dword s61, s[14:15], 65280
    s_mov_b32 s36, s14
    s_and_b32 s37, s15, 0xffff
    s_mov_b32 s38, 12582912
    s_mov_b32 s39, 0x20000
    s_cmp_lt_u32 s44, 14
    s_cselect_b32 s3, 0, 2
    s_xor_b32 s47, s47, s3
    s_and_b32 s4, s46, 1
    s_lshr_b32 s5, s46, 1
    v_lshlrev_b32 v1, 4, v0
    v_and_b32 v15, 3, v0
    v_and_b32 v2, 31, v0
    v_lshlrev_b32 v17, 4, v2
    v_lshlrev_b32 v2, 7, v2
    v_bfe_u32 v3, v0, 1, 3
    v_lshrrev_b32 v4, 5, v0
    v_mul_u32_u24 v18, 8960, v4
    v_add_u32 v17, v17, v18
    v_xor_b32 v3, v3, v4
    v_lshl_add_u32 v2, v3, 4, v2
    s_lshl_b32 s3, s4, 12
    v_add_u32 v2, s3, v2
    v_bfe_u32 v20, v0, 2, 2
    v_lshl_add_u32 v21, v4, 3, v20
    v_xor_b32 v3, 32, v2
    v_xor_b32 v4, 64, v2
    v_xor_b32 v5, 96, v2
    s_mul_i32 s3, s5, 57344
    v_add_u32 v6, s3, v2
    v_add_u32 v7, s3, v3
    v_add_u32 v8, s3, v4
    v_add_u32 v9, s3, v5
    v_bfe_u32 v22, v0, 4, 1
    v_lshlrev_b32 v22, 5, v22
    v_lshrrev_b32 v23, 1, v15
    v_and_b32 v24, 1, v15
    v_lshl_add_u32 v23, v24, 1, v23
    v_lshl_add_u32 v23, v23, 3, v22
    v_lshl_add_u32 v24, v15, 3, v22
    v_lshl_add_u32 v11, v21, 6, v23
    v_add_u32 v11, 114688, v11
    s_cmp_lt_u32 s44, 7
    s_cselect_b64 vcc, -1, 0
    v_cndmask_b32 v23, v24, v23, vcc
    v_lshrrev_b32 v20, 1, v20
    v_xor_b32 v20, s5, v20
    v_lshl_add_u32 v23, v20, 6, v23
    v_lshl_add_u32 v10, v21, 7, v23
    v_add_u32 v10, 57344, v10
    s_lshl_b32 s3, s46, 12
    s_sub_u32 s3, 159744, s3
    v_mov_b32 v14, s3
    s_lshl1_add_u32 s5, s44, s5
    s_and_b32 s3, s45, 1
    s_lshl1_add_u32 s4, s3, s4
    s_lshr_b32 s60, s45, 1
    s_lshl4_add_u32 s51, s4, s60
    s_lshl_b32 s51, s51, 16
    s_lshl4_add_u32 s3, s5, s4
    v_lshl_add_u32 v12, v0, 2, s3
    v_lshlrev_b32 v12, 8, v12
    v_add_u32 v12, 5242880, v12
    s_lshl_b32 s53, s47, 8
    s_add_u32 s53, s53, 5373952
    v_mov_b32 v13, s53
    v_writelane_b32 v12, s53, 4
    v_bfe_u32 v19, v0, 3, 2
    v_mul_u32_u24 v19, 8960, v19
    v_lshrrev_b32 v20, 5, v0
    v_lshl_add_u32 v19, v20, 19, v19
    v_and_b32 v20, 7, v0
    v_lshl_add_u32 v19, v20, 4, v19
    v_cmp_eq_u32 vcc, 0, v20
    v_mov_b32 v21, 0x3f803f80
    s_nop 0
    v_cndmask_b32 v26, 0, v21, vcc
    v_cndmask_b32 v27, 0, v21, vcc
    v_cndmask_b32 v28, 0, v21, vcc
    v_cndmask_b32 v29, 0, v21, vcc
    s_mov_b32 s28, s10
    s_and_b32 s29, s11, 0xffff
    s_mov_b32 s30, 1835008
    s_mov_b32 s31, 0x20000
    s_mov_b32 s40, s14
    s_and_b32 s41, s15, 0xffff
    s_mov_b32 s42, 4194304
    s_mov_b32 s43, 0x20000
    s_waitcnt lgkmcnt(0)
    s_xor_b32 s61, s61, 0x5ac3a53c
    v_mov_b32 v250, 0
    v_mov_b32 v251, s61
    s_cmp_ge_u32 s45, 2
    s_cbranch_scc1 L_noopen1
    s_mov_b64 exec, 15
    buffer_atomic_swap_x2 v[250:251], v12, s[36:39], 0 offen sc1
L_noopen1:
    s_cmp_lg_u32 s44, 15
    s_cbranch_scc1 L_noopen2
    s_mov_b64 exec, 1
    buffer_atomic_swap_x2 v[250:251], v13, s[36:39], 0 offen sc1
L_noopen2:
    s_mov_b64 exec, -1
    s_lshl_b32 s3, s46, 20
    s_add_u32 s16, s14, s3
    s_addc_u32 s17, s15, 0
    s_and_b32 s17, s17, 0xffff
    s_mov_b32 s18, 1048576
    s_mov_b32 s19, 0x20000
    s_mul_i32 s6, s44, 56
    s_lshr_b32 s7, s6, 4
    s_lshl_b32 s7, s7, 9
    v_add_u32 v16, s7, v1
    s_lshr_b32 s6, s6, 1
    v_and_b32 v20, 31, v0
    v_add_u32 v21, s6, v20
    v_lshrrev_b32 v22, 5, v21
    v_lshl_add_u32 v21, v22, 3, v21
    s_lshr_b32 s7, s6, 5
    s_mul_i32 s7, s7, 40
    s_add_u32 s7, s7, 4
    v_add_u32 v22, s7, v20
    v_cmp_gt_u32 vcc, 28, v20
    v_add_u32 v25, 28672, v18
    s_nop 0
    v_cndmask_b32 v21, v22, v21, vcc
    v_lshl_add_u32 v24, v21, 4, v25
    v_add_u32 v25, 17920, v24
    s_lshr_b32 s3, s45, 2
    s_lshl1_add_u32 s3, s45, s3
    s_and_b32 s57, s3, 7
    s_mov_b32 s48, 0
    s_mov_b32 s49, 0x7ffff
    v_add_u32 v20, v14, v1
    s_mul_i32 s3, s46, 12288
    s_add_u32 s11, s3, 114688
    s_add_u32 s53, s46, 1
    s_and_b32 s53, s53, 3
    s_mul_i32 s3, s53, 12288
    s_add_u32 s8, s3, 114688
    s_lshl_b32 s53, s53, 12
    s_sub_u32 s53, 159744, s53
    v_add_u32 v21, s53, v1
    s_add_u32 s53, s46, 2
    s_and_b32 s53, s53, 3
    s_mul_i32 s3, s53, 12288
    s_add_u32 s9, s3, 118784
    s_lshl_b32 s53, s53, 12
    s_sub_u32 s53, 159744, s53
    v_add_u32 v22, s53, v1
    s_add_u32 s53, s46, 3
    s_and_b32 s53, s53, 3
    s_mul_i32 s3, s53, 12288
    s_add_u32 s10, s3, 122880
    s_lshl_b32 s53, s53, 12
    s_sub_u32 s53, 159744, s53
    v_add_u32 v23, s53, v1
    v_mov_b32 v30, 0
    v_mov_b32 v31, 0
    v_pk_mov_b32 v[244:245], v[30:31], v[30:31]
    v_pk_mov_b32 v[246:247], v[30:31], v[30:31]
    s_cmp_lt_u32 s44, 7
    s_cbranch_scc0 L_vline
    s_lshl_b32 s3, s5, 11
    s_add_u32 s51, s51, s3
    s_barrier
    ds_read_b128 v[176:179], v2 offset:0
    ds_read_b64_tr_b16 v[64:65], v10 offset:0
    ds_read_b64_tr_b16 v[66:67], v10 offset:512
    ds_read_b128 v[180:183], v3 offset:0
    ds_read_b64_tr_b16 v[68:69], v10 offset:2048
    ds_read_b64_tr_b16 v[70:71], v10 offset:2560
    ds_read_b128 v[184:187], v4 offset:0
    ds_read_b64_tr_b16 v[72:73], v10 offset:4096
    ds_read_b64_tr_b16 v[74:75], v10 offset:4608
    s_waitcnt lgkmcnt(6)
    ds_read_b128 v[188:191], v5 offset:0
    ds_read_b64_tr_b16 v[76:77], v10 offset:6144
    ds_read_b64_tr_b16 v[78:79], v10 offset:6656
    v_mfma_f32_32x32x16_bf16 v[32:47], v[64:67], v[176:179], 0
    s_waitcnt lgkmcnt(6)
    v_mfma_f32_32x32x16_bf16 v[32:47], v[68:71], v[180:183], v[32:47]
    s_waitcnt lgkmcnt(0)
    s_barrier
    ds_read_b128 v[176:179], v2 offset:8192
    ds_read_b64_tr_b16 v[80:81], v10 offset:8192
    ds_read_b64_tr_b16 v[82:83], v10 offset:8704
    ds_read_b128 v[180:183], v3 offset:8192
    ds_read_b64_tr_b16 v[84:85], v10 offset:10240
    ds_read_b64_tr_b16 v[86:87], v10 offset:10752
    v_mfma_f32_32x32x16_bf16 v[32:47], v[72:75], v[184:187], v[32:47]
    ds_read_b128 v[184:187], v4 offset:8192
    ds_read_b64_tr_b16 v[88:89], v10 offset:12288
    ds_read_b64_tr_b16 v[90:91], v10 offset:12800
    v_mfma_f32_32x32x16_bf16 v[32:47], v[76:79], v[188:191], v[32:47]
    s_waitcnt lgkmcnt(6)
    ds_read_b128 v[188:191], v5 offset:8192
    ds_read_b64_tr_b16 v[92:93], v10 offset:14336
    ds_read_b64_tr_b16 v[94:95], v10 offset:14848
    v_mfma_f32_32x32x16_bf16 v[32:47], v[80:83], v[176:179], v[32:47]
    s_waitcnt lgkmcnt(6)
    v_mfma_f32_32x32x16_bf16 v[32:47], v[84:87], v[180:183], v[32:47]
    s_waitcnt lgkmcnt(0)
    s_barrier
    ds_read_b128 v[176:179], v2 offset:16384
    ds_read_b64_tr_b16 v[96:97], v10 offset:16384
    ds_read_b64_tr_b16 v[98:99], v10 offset:16896
    ds_read_b128 v[180:183], v3 offset:16384
    ds_read_b64_tr_b16 v[100:101], v10 offset:18432
    ds_read_b64_tr_b16 v[102:103], v10 offset:18944
    v_mfma_f32_32x32x16_bf16 v[32:47], v[88:91], v[184:187], v[32:47]
    ds_read_b128 v[184:187], v4 offset:16384
    ds_read_b64_tr_b16 v[104:105], v10 offset:20480
    ds_read_b64_tr_b16 v[106:107], v10 offset:20992
    v_mfma_f32_32x32x16_bf16 v[32:47], v[92:95], v[188:191], v[32:47]
    s_waitcnt lgkmcnt(6)
    ds_read_b128 v[188:191], v5 offset:16384
    ds_read_b64_tr_b16 v[108:109], v10 offset:22528
    ds_read_b64_tr_b16 v[110:111], v10 offset:23040
    v_mfma_f32_32x32x16_bf16 v[32:47], v[96:99], v[176:179], v[32:47]
    s_waitcnt lgkmcnt(6)
    v_mfma_f32_32x32x16_bf16 v[32:47], v[100:103], v[180:183], v[32:47]
    s_waitcnt lgkmcnt(0)
    s_barrier
    ds_read_b128 v[176:179], v2 offset:24576
    ds_read_b64_tr_b16 v[112:113], v10 offset:24576
    ds_read_b64_tr_b16 v[114:115], v10 offset:25088
    ds_read_b128 v[180:183], v3 offset:24576
    ds_read_b64_tr_b16 v[116:117], v10 offset:26624
    ds_read_b64_tr_b16 v[118:119], v10 offset:27136
    v_mfma_f32_32x32x16_bf16 v[32:47], v[104:107], v[184:187], v[32:47]
    ds_read_b128 v[184:187], v4 offset:24576
    ds_read_b64_tr_b16 v[120:121], v10 offset:28672
    ds_read_b64_tr_b16 v[122:123], v10 offset:29184
    v_mfma_f32_32x32x16_bf16 v[32:47], v[108:111], v[188:191], v[32:47]
    s_waitcnt lgkmcnt(6)
    ds_read_b128 v[188:191], v5 offset:24576
    ds_read_b64_tr_b16 v[124:125], v10 offset:30720
    ds_read_b64_tr_b16 v[126:127], v10 offset:31232
    v_mfma_f32_32x32x16_bf16 v[32:47], v[112:115], v[176:179], v[32:47]
    s_waitcnt lgkmcnt(6)
    v_mfma_f32_32x32x16_bf16 v[32:47], v[116:119], v[180:183], v[32:47]
    s_waitcnt lgkmcnt(0)
    s_barrier
    ds_read_b128 v[176:179], v2 offset:32768
    ds_read_b64_tr_b16 v[128:129], v10 offset:32768
    ds_read_b64_tr_b16 v[130:131], v10 offset:33280
    ds_read_b128 v[180:183], v3 offset:32768
    ds_read_b64_tr_b16 v[132:133], v10 offset:34816
    ds_read_b64_tr_b16 v[134:135], v10 offset:35328
    v_mfma_f32_32x32x16_bf16 v[32:47], v[120:123], v[184:187], v[32:47]
    ds_read_b128 v[184:187], v4 offset:32768
    ds_read_b64_tr_b16 v[136:137], v10 offset:36864
    ds_read_b64_tr_b16 v[138:139], v10 offset:37376
    v_mfma_f32_32x32x16_bf16 v[32:47], v[124:127], v[188:191], v[32:47]
    s_waitcnt lgkmcnt(6)
    ds_read_b128 v[188:191], v5 offset:32768
    ds_read_b64_tr_b16 v[140:141], v10 offset:38912
    ds_read_b64_tr_b16 v[142:143], v10 offset:39424
    v_mfma_f32_32x32x16_bf16 v[32:47], v[128:131], v[176:179], v[32:47]
    s_waitcnt lgkmcnt(6)
    v_mfma_f32_32x32x16_bf16 v[32:47], v[132:135], v[180:183], v[32:47]
    s_waitcnt lgkmcnt(0)
    s_barrier
    ds_read_b128 v[176:179], v2 offset:40960
    ds_read_b64_tr_b16 v[144:145], v10 offset:40960
    ds_read_b64_tr_b16 v[146:147], v10 offset:41472
    ds_read_b128 v[180:183], v3 offset:40960
    ds_read_b64_tr_b16 v[148:149], v10 offset:43008
    ds_read_b64_tr_b16 v[150:151], v10 offset:43520
    v_mfma_f32_32x32x16_bf16 v[32:47], v[136:139], v[184:187], v[32:47]
    ds_read_b128 v[184:187], v4 offset:40960
    ds_read_b64_tr_b16 v[152:153], v10 offset:45056
    ds_read_b64_tr_b16 v[154:155], v10 offset:45568
    v_mfma_f32_32x32x16_bf16 v[32:47], v[140:143], v[188:191], v[32:47]
    s_waitcnt lgkmcnt(6)
    ds_read_b128 v[188:191], v5 offset:40960
    ds_read_b64_tr_b16 v[156:157], v10 offset:47104
    ds_read_b64_tr_b16 v[158:159], v10 offset:47616
    v_mfma_f32_32x32x16_bf16 v[32:47], v[144:147], v[176:179], v[32:47]
    s_waitcnt lgkmcnt(6)
    v_mfma_f32_32x32x16_bf16 v[32:47], v[148:151], v[180:183], v[32:47]
    s_waitcnt lgkmcnt(3)
    v_mfma_f32_32x32x16_bf16 v[32:47], v[152:155], v[184:187], v[32:47]
    s_waitcnt lgkmcnt(0)
    v_mfma_f32_32x32x16_bf16 v[32:47], v[156:159], v[188:191], v[32:47]
    s_barrier
    ds_read_b128 v[176:179], v2 offset:49152
    ds_read_b64_tr_b16 v[160:161], v10 offset:49152
    ds_read_b64_tr_b16 v[162:163], v10 offset:49664
    ds_read_b128 v[180:183], v3 offset:49152
    ds_read_b64_tr_b16 v[164:165], v10 offset:51200
    ds_read_b64_tr_b16 v[166:167], v10 offset:51712
    ds_read_b128 v[184:187], v4 offset:49152
    ds_read_b64_tr_b16 v[168:169], v10 offset:53248
    ds_read_b64_tr_b16 v[170:171], v10 offset:53760
    s_waitcnt lgkmcnt(6)
    ds_read_b128 v[188:191], v5 offset:49152
    ds_read_b64_tr_b16 v[172:173], v10 offset:55296
    ds_read_b64_tr_b16 v[174:175], v10 offset:55808
    v_mfma_f32_32x32x16_bf16 v[32:47], v[160:163], v[176:179], v[32:47]
    s_waitcnt lgkmcnt(6)
    v_mfma_f32_32x32x16_bf16 v[32:47], v[164:167], v[180:183], v[32:47]
    s_waitcnt lgkmcnt(3)
    v_mfma_f32_32x32x16_bf16 v[32:47], v[168:171], v[184:187], v[32:47]
    s_waitcnt lgkmcnt(0)
    v_mfma_f32_32x32x16_bf16 v[32:47], v[172:175], v[188:191], v[32:47]
    v_add_u32 v2, 57344, v2
    v_add_u32 v3, 57344, v3
    v_add_u32 v4, 57344, v4
    v_add_u32 v5, 57344, v5
    s_nop 7
    v_cvt_pk_bf16_f32 v224, v32, v33
    v_cvt_pk_bf16_f32 v225, v34, v35
    v_cvt_pk_bf16_f32 v226, v36, v37
    v_cvt_pk_bf16_f32 v227, v38, v39
    buffer_store_dwordx4 v[224:227], v1, s[40:43], s51 offen offset:0 sc1
    v_cvt_pk_bf16_f32 v228, v40, v41
    v_cvt_pk_bf16_f32 v229, v42, v43
    v_cvt_pk_bf16_f32 v230, v44, v45
    v_cvt_pk_bf16_f32 v231, v46, v47
    buffer_store_dwordx4 v[228:231], v1, s[40:43], s51 offen offset:1024 sc1
    s_add_u32 s51, s51, 524288
    s_mov_b32 s56, 0
    s_barrier
    ds_read_b128 v[176:179], v2 offset:0
    ds_read_b128 v[184:187], v3 offset:0
    ds_read_b128 v[192:195], v4 offset:0
    ds_read_b128 v[200:203], v5 offset:0
    ds_read_b128 v[208:211], v2 offset:8192
    s_waitcnt lgkmcnt(4)
    v_mfma_f32_32x32x16_bf16 v[32:47], v[64:67], v[176:179], 0
    ds_read_b128 v[216:219], v3 offset:8192
    s_waitcnt lgkmcnt(4)
    v_mfma_f32_32x32x16_bf16 v[32:47], v[68:71], v[184:187], v[32:47]
    ds_read_b128 v[176:179], v4 offset:8192
    s_waitcnt lgkmcnt(4)
    v_mfma_f32_32x32x16_bf16 v[32:47], v[72:75], v[192:195], v[32:47]
    ds_read_b128 v[184:187], v5 offset:8192
    s_waitcnt lgkmcnt(4)
    v_mfma_f32_32x32x16_bf16 v[32:47], v[76:79], v[200:203], v[32:47]
    s_barrier
    ds_read_b128 v[192:195], v2 offset:16384
    s_waitcnt lgkmcnt(4)
    v_mfma_f32_32x32x16_bf16 v[32:47], v[80:83], v[208:211], v[32:47]
    ds_read_b128 v[200:203], v3 offset:16384
    s_waitcnt lgkmcnt(4)
    v_mfma_f32_32x32x16_bf16 v[32:47], v[84:87], v[216:219], v[32:47]
    ds_read_b128 v[208:211], v4 offset:16384
    s_waitcnt lgkmcnt(4)
    v_mfma_f32_32x32x16_bf16 v[32:47], v[88:91], v[176:179], v[32:47]
    ds_read_b128 v[216:219], v5 offset:16384
    s_waitcnt lgkmcnt(4)
    v_mfma_f32_32x32x16_bf16 v[32:47], v[92:95], v[184:187], v[32:47]
    ds_read_b128 v[176:179], v2 offset:24576
    s_waitcnt lgkmcnt(4)
    v_mfma_f32_32x32x16_bf16 v[32:47], v[96:99], v[192:195], v[32:47]
    ds_read_b128 v[184:187], v3 offset:24576
    s_waitcnt lgkmcnt(4)
    v_mfma_f32_32x32x16_bf16 v[32:47], v[100:103], v[200:203], v[32:47]
    ds_read_b128 v[192:195], v4 offset:24576
    s_waitcnt lgkmcnt(4)
    v_mfma_f32_32x32x16_bf16 v[32:47], v[104:107], v[208:211], v[32:47]
    ds_read_b128 v[200:203], v5 offset:24576
    s_waitcnt lgkmcnt(4)
    v_mfma_f32_32x32x16_bf16 v[32:47], v[108:111], v[216:219], v[32:47]
    s_barrier
    s_waitcnt vmcnt(0)
    s_lshl_b32 s3, 1, s60
    v_mov_b32 v250, s3
    v_mov_b32 v251, 0
    v_writelane_b32 v250, 0, 4
    s_mov_b64 exec, 31
    buffer_atomic_or_x2 v[250:251], v12, s[36:39], 0 offen sc0 sc1
    s_mov_b64 exec, -1
    ds_read_b128 v[208:211], v2 offset:32768
    s_waitcnt lgkmcnt(4)
    v_mfma_f32_32x32x16_bf16 v[32:47], v[112:115], v[176:179], v[32:47]
    ds_read_b128 v[216:219], v3 offset:32768
    s_waitcnt lgkmcnt(4)
    v_mfma_f32_32x32x16_bf16 v[32:47], v[116:119], v[184:187], v[32:47]
    ds_read_b128 v[176:179], v4 offset:32768
    s_waitcnt lgkmcnt(4)
    v_mfma_f32_32x32x16_bf16 v[32:47], v[120:123], v[192:195], v[32:47]
    ds_read_b128 v[184:187], v5 offset:32768
    s_waitcnt lgkmcnt(4)
    v_mfma_f32_32x32x16_bf16 v[32:47], v[124:127], v[200:203], v[32:47]
    ds_read_b128 v[192:195], v2 offset:40960
    s_waitcnt lgkmcnt(4)
    v_mfma_f32_32x32x16_bf16 v[32:47], v[128:131], v[208:211], v[32:47]
    ds_read_b128 v[200:203], v3 offset:40960
    s_waitcnt lgkmcnt(4)
    v_mfma_f32_32x32x16_bf16 v[32:47], v[132:135], v[216:219], v[32:47]
    ds_read_b128 v[208:211], v4 offset:40960
    s_waitcnt lgkmcnt(4)
    v_mfma_f32_32x32x16_bf16 v[32:47], v[136:139], v[176:179], v[32:47]
    ds_read_b128 v[216:219], v5 offset:40960
    s_waitcnt lgkmcnt(4)
    v_mfma_f32_32x32x16_bf16 v[32:47], v[140:143], v[184:187], v[32:47]
    s_barrier
    ds_read_b128 v[176:179], v2 offset:49152
    s_waitcnt lgkmcnt(4)
    v_mfma_f32_32x32x16_bf16 v[32:47], v[144:147], v[192:195], v[32:47]
    ds_read_b128 v[184:187], v3 offset:49152
    s_waitcnt lgkmcnt(4)
    v_mfma_f32_32x32x16_bf16 v[32:47], v[148:151], v[200:203], v[32:47]
    ds_read_b128 v[192:195], v4 offset:49152
    s_waitcnt lgkmcnt(4)
    v_mfma_f32_32x32x16_bf16 v[32:47], v[152:155], v[208:211], v[32:47]
    ds_read_b128 v[200:203], v5 offset:49152
    s_waitcnt lgkmcnt(4)
    v_mfma_f32_32x32x16_bf16 v[32:47], v[156:159], v[216:219], v[32:47]
    ds_read_b128 v[208:211], v6 offset:0
    ds_read_b64_tr_b16 v[212:213], v11 offset:0
    ds_read_b64_tr_b16 v[214:215], v11 offset:256
    s_waitcnt lgkmcnt(6)
    v_mfma_f32_32x32x16_bf16 v[32:47], v[160:163], v[176:179], v[32:47]
    ds_read_b128 v[216:219], v7 offset:0
    ds_read_b64_tr_b16 v[220:221], v11 offset:1024
    ds_read_b64_tr_b16 v[222:223], v11 offset:1280
    s_waitcnt lgkmcnt(8)
    v_mfma_f32_32x32x16_bf16 v[32:47], v[164:167], v[184:187], v[32:47]
    ds_read_b128 v[176:179], v8 offset:0
    ds_read_b64_tr_b16 v[180:181], v11 offset:2048
    ds_read_b64_tr_b16 v[182:183], v11 offset:2304
    s_waitcnt lgkmcnt(10)
    v_mfma_f32_32x32x16_bf16 v[32:47], v[168:171], v[192:195], v[32:47]
    ds_read_b128 v[184:187], v9 offset:0
    ds_read_b64_tr_b16 v[188:189], v11 offset:3072
    ds_read_b64_tr_b16 v[190:191], v11 offset:3328
    s_waitcnt lgkmcnt(12)
    v_mfma_f32_32x32x16_bf16 v[32:47], v[172:175], v[200:203], v[32:47]
    ds_read_b128 v[192:195], v6 offset:8192
    ds_read_b64_tr_b16 v[196:197], v11 offset:4096
    ds_read_b64_tr_b16 v[198:199], v11 offset:4352
    s_waitcnt lgkmcnt(12)
    v_mfma_f32_32x32x16_bf16 v[48:63], v[212:215], v[208:211], 0
    ds_read_b128 v[200:203], v7 offset:8192
    ds_read_b64_tr_b16 v[204:205], v11 offset:5120
    ds_read_b64_tr_b16 v[206:207], v11 offset:5376
    s_waitcnt lgkmcnt(12)
    v_mfma_f32_32x32x16_bf16 v[48:63], v[220:223], v[216:219], v[48:63]
    ds_read_b128 v[208:211], v8 offset:8192
    ds_read_b64_tr_b16 v[212:213], v11 offset:6144
    ds_read_b64_tr_b16 v[214:215], v11 offset:6400
    s_waitcnt lgkmcnt(12)
    v_mfma_f32_32x32x16_bf16 v[48:63], v[180:183], v[176:179], v[48:63]
    ds_read_b128 v[216:219], v9 offset:8192
    ds_read_b64_tr_b16 v[220:221], v11 offset:7168
    ds_read_b64_tr_b16 v[222:223], v11 offset:7424
    s_waitcnt lgkmcnt(12)
    v_mfma_f32_32x32x16_bf16 v[48:63], v[188:191], v[184:187], v[48:63]
    s_barrier
    ds_read_b128 v[176:179], v6 offset:16384
    ds_read_b64_tr_b16 v[180:181], v11 offset:8192
    ds_read_b64_tr_b16 v[182:183], v11 offset:8448
    s_waitcnt lgkmcnt(12)
    v_mfma_f32_32x32x16_bf16 v[48:63], v[196:199], v[192:195], v[48:63]
    ds_read_b128 v[184:187], v7 offset:16384
    ds_read_b64_tr_b16 v[188:189], v11 offset:9216
    ds_read_b64_tr_b16 v[190:191], v11 offset:9472
    s_waitcnt lgkmcnt(12)
    v_mfma_f32_32x32x16_bf16 v[48:63], v[204:207], v[200:203], v[48:63]
    ds_read_b128 v[192:195], v8 offset:16384
    ds_read_b64_tr_b16 v[196:197], v11 offset:10240
    ds_read_b64_tr_b16 v[198:199], v11 offset:10496
    s_waitcnt lgkmcnt(12)
    v_mfma_f32_32x32x16_bf16 v[48:63], v[212:215], v[208:211], v[48:63]
    v_cvt_pk_bf16_f32 v232, v32, v33
    v_cvt_pk_bf16_f32 v233, v34, v35
    v_cvt_pk_bf16_f32 v234, v36, v37
    v_cvt_pk_bf16_f32 v235, v38, v39
    buffer_store_dwordx4 v[232:235], v1, s[40:43], s51 offen offset:0 sc1
    v_cvt_pk_bf16_f32 v236, v40, v41
    v_cvt_pk_bf16_f32 v237, v42, v43
    v_cvt_pk_bf16_f32 v238, v44, v45
    v_cvt_pk_bf16_f32 v239, v46, v47
    buffer_store_dwordx4 v[236:239], v1, s[40:43], s51 offen offset:1024 sc1
    ds_read_b128 v[200:203], v9 offset:16384
    ds_read_b64_tr_b16 v[204:205], v11 offset:11264
    ds_read_b64_tr_b16 v[206:207], v11 offset:11520
    s_waitcnt lgkmcnt(12)
    v_mfma_f32_32x32x16_bf16 v[48:63], v[220:223], v[216:219], v[48:63]
    ds_read_b128 v[208:211], v6 offset:24576
    ds_read_b64_tr_b16 v[212:213], v11 offset:12288
    ds_read_b64_tr_b16 v[214:215], v11 offset:12544
    s_waitcnt lgkmcnt(12)
    v_mfma_f32_32x32x16_bf16 v[48:63], v[180:183], v[176:179], v[48:63]
    ds_read_b128 v[216:219], v7 offset:24576
    ds_read_b64_tr_b16 v[220:221], v11 offset:13312
    ds_read_b64_tr_b16 v[222:223], v11 offset:13568
    s_waitcnt lgkmcnt(12)
    v_mfma_f32_32x32x16_bf16 v[48:63], v[188:191], v[184:187], v[48:63]
    ds_read_b128 v[176:179], v8 offset:24576
    ds_read_b64_tr_b16 v[180:181], v11 offset:14336
    ds_read_b64_tr_b16 v[182:183], v11 offset:14592
    s_waitcnt lgkmcnt(12)
    v_mfma_f32_32x32x16_bf16 v[48:63], v[196:199], v[192:195], v[48:63]
    ds_read_b128 v[184:187], v9 offset:24576
    ds_read_b64_tr_b16 v[188:189], v11 offset:15360
    ds_read_b64_tr_b16 v[190:191], v11 offset:15616
    s_waitcnt lgkmcnt(12)
    v_mfma_f32_32x32x16_bf16 v[48:63], v[204:207], v[200:203], v[48:63]
    s_barrier
    ds_read_b128 v[192:195], v6 offset:32768
    ds_read_b64_tr_b16 v[196:197], v11 offset:16384
    ds_read_b64_tr_b16 v[198:199], v11 offset:16640
    s_waitcnt lgkmcnt(12)
    v_mfma_f32_32x32x16_bf16 v[48:63], v[212:215], v[208:211], v[48:63]
    ds_read_b128 v[200:203], v7 offset:32768
    ds_read_b64_tr_b16 v[204:205], v11 offset:17408
    ds_read_b64_tr_b16 v[206:207], v11 offset:17664
    s_waitcnt lgkmcnt(12)
    v_mfma_f32_32x32x16_bf16 v[48:63], v[220:223], v[216:219], v[48:63]
    ds_read_b128 v[208:211], v8 offset:32768
    ds_read_b64_tr_b16 v[212:213], v11 offset:18432
    ds_read_b64_tr_b16 v[214:215], v11 offset:18688
    s_waitcnt lgkmcnt(12)
    v_mfma_f32_32x32x16_bf16 v[48:63], v[180:183], v[176:179], v[48:63]
    ds_read_b128 v[216:219], v9 offset:32768
    ds_read_b64_tr_b16 v[220:221], v11 offset:19456
    ds_read_b64_tr_b16 v[222:223], v11 offset:19712
    s_waitcnt lgkmcnt(12)
    v_mfma_f32_32x32x16_bf16 v[48:63], v[188:191], v[184:187], v[48:63]
    ds_read_b128 v[176:179], v6 offset:40960
    ds_read_b64_tr_b16 v[180:181], v11 offset:20480
    ds_read_b64_tr_b16 v[182:183], v11 offset:20736
    s_waitcnt lgkmcnt(12)
    v_mfma_f32_32x32x16_bf16 v[48:63], v[196:199], v[192:195], v[48:63]
    ds_read_b128 v[184:187], v7 offset:40960
    ds_read_b64_tr_b16 v[188:189], v11 offset:21504
    ds_read_b64_tr_b16 v[190:191], v11 offset:21760
    s_waitcnt lgkmcnt(12)
    v_mfma_f32_32x32x16_bf16 v[48:63], v[204:207], v[200:203], v[48:63]
    ds_read_b128 v[192:195], v8 offset:40960
    ds_read_b64_tr_b16 v[196:197], v11 offset:22528
    ds_read_b64_tr_b16 v[198:199], v11 offset:22784
    s_waitcnt lgkmcnt(12)
    v_mfma_f32_32x32x16_bf16 v[48:63], v[212:215], v[208:211], v[48:63]
    ds_read_b128 v[200:203], v9 offset:40960
    ds_read_b64_tr_b16 v[204:205], v11 offset:23552
    ds_read_b64_tr_b16 v[206:207], v11 offset:23808
    s_waitcnt lgkmcnt(12)
    v_mfma_f32_32x32x16_bf16 v[48:63], v[220:223], v[216:219], v[48:63]
    s_barrier
    s_mov_b32 s59, 0x100000
    s_waitcnt vmcnt(2)
L_fc1K:
    s_mov_b64 exec, 31
    v_cmp_ne_u32 vcc, s61, v251
    s_mov_b64 exec, -1
    s_cbranch_vccnz L_fc1K_again
L_fc1K_ok:
    ds_read_b128 v[208:211], v6 offset:49152
    ds_read_b64_tr_b16 v[212:213], v11 offset:24576
    ds_read_b64_tr_b16 v[214:215], v11 offset:24832
    s_waitcnt lgkmcnt(12)
    v_mfma_f32_32x32x16_bf16 v[48:63], v[180:183], v[176:179], v[48:63]
    ds_read_b128 v[216:219], v7 offset:49152
    ds_read_b64_tr_b16 v[220:221], v11 offset:25600
    ds_read_b64_tr_b16 v[222:223], v11 offset:25856
    s_waitcnt lgkmcnt(12)
    v_mfma_f32_32x32x16_bf16 v[48:63], v[188:191], v[184:187], v[48:63]
    ds_read_b128 v[176:179], v8 offset:49152
    ds_read_b64_tr_b16 v[180:181], v11 offset:26624
    ds_read_b64_tr_b16 v[182:183], v11 offset:26880
    s_waitcnt lgkmcnt(12)
    v_mfma_f32_32x32x16_bf16 v[48:63], v[196:199], v[192:195], v[48:63]
    ds_read_b128 v[184:187], v9 offset:49152
    ds_read_b64_tr_b16 v[188:189], v11 offset:27648
    ds_read_b64_tr_b16 v[190:191], v11 offset:27904
    s_waitcnt lgkmcnt(12)
    v_mfma_f32_32x32x16_bf16 v[48:63], v[204:207], v[200:203], v[48:63]
    s_waitcnt lgkmcnt(9)
    v_mfma_f32_32x32x16_bf16 v[48:63], v[212:215], v[208:211], v[48:63]
    ds_read_b32 v15, v14
    s_waitcnt lgkmcnt(7)
    v_mfma_f32_32x32x16_bf16 v[48:63], v[220:223], v[216:219], v[48:63]
    s_waitcnt lgkmcnt(4)
    v_mfma_f32_32x32x16_bf16 v[48:63], v[180:183], v[176:179], v[48:63]
    s_waitcnt lgkmcnt(0)
    v_mfma_f32_32x32x16_bf16 v[48:63], v[188:191], v[184:187], v[48:63]
    s_branch L_q
L_vline:
    s_mul_i32 s3, s5, 640
    s_add_u32 s51, s51, s3
    s_add_u32 s51, s51, 19712
    s_cmp_lt_u32 s44, 14
    s_cselect_b32 s42, 4194304, 0
    s_barrier
    ds_read_b128 v[176:179], v2 offset:0
    ds_read_b64_tr_b16 v[64:65], v10 offset:0
    ds_read_b64_tr_b16 v[66:67], v10 offset:512
    ds_read_b128 v[180:183], v3 offset:0
    ds_read_b64_tr_b16 v[68:69], v10 offset:2048
    ds_read_b64_tr_b16 v[70:71], v10 offset:2560
    ds_read_b128 v[184:187], v4 offset:0
    ds_read_b64_tr_b16 v[72:73], v10 offset:4096
    ds_read_b64_tr_b16 v[74:75], v10 offset:4608
    s_waitcnt lgkmcnt(6)
    ds_read_b128 v[188:191], v5 offset:0
    ds_read_b64_tr_b16 v[76:77], v10 offset:6144
    ds_read_b64_tr_b16 v[78:79], v10 offset:6656
    v_mfma_f32_32x32x16_bf16 v[32:47], v[176:179], v[64:67], 0
    s_waitcnt lgkmcnt(6)
    v_mfma_f32_32x32x16_bf16 v[32:47], v[180:183], v[68:71], v[32:47]
    s_waitcnt lgkmcnt(0)
    s_barrier
    ds_read_b128 v[176:179], v2 offset:8192
    ds_read_b64_tr_b16 v[80:81], v10 offset:8192
    ds_read_b64_tr_b16 v[82:83], v10 offset:8704
    ds_read_b128 v[180:183], v3 offset:8192
    ds_read_b64_tr_b16 v[84:85], v10 offset:10240
    ds_read_b64_tr_b16 v[86:87], v10 offset:10752
    v_mfma_f32_32x32x16_bf16 v[32:47], v[184:187], v[72:75], v[32:47]
    ds_read_b128 v[184:187], v4 offset:8192
    ds_read_b64_tr_b16 v[88:89], v10 offset:12288
    ds_read_b64_tr_b16 v[90:91], v10 offset:12800
    v_mfma_f32_32x32x16_bf16 v[32:47], v[188:191], v[76:79], v[32:47]
    s_waitcnt lgkmcnt(6)
    ds_read_b128 v[188:191], v5 offset:8192
    ds_read_b64_tr_b16 v[92:93], v10 offset:14336
    ds_read_b64_tr_b16 v[94:95], v10 offset:14848
    v_mfma_f32_32x32x16_bf16 v[32:47], v[176:179], v[80:83], v[32:47]
    s_waitcnt lgkmcnt(6)
    v_mfma_f32_32x32x16_bf16 v[32:47], v[180:183], v[84:87], v[32:47]
    s_waitcnt lgkmcnt(0)
    s_barrier
    ds_read_b128 v[176:179], v2 offset:16384
    ds_read_b64_tr_b16 v[96:97], v10 offset:16384
    ds_read_b64_tr_b16 v[98:99], v10 offset:16896
    ds_read_b128 v[180:183], v3 offset:16384
    ds_read_b64_tr_b16 v[100:101], v10 offset:18432
    ds_read_b64_tr_b16 v[102:103], v10 offset:18944
    v_mfma_f32_32x32x16_bf16 v[32:47], v[184:187], v[88:91], v[32:47]
    ds_read_b128 v[184:187], v4 offset:16384
    ds_read_b64_tr_b16 v[104:105], v10 offset:20480
    ds_read_b64_tr_b16 v[106:107], v10 offset:20992
    v_mfma_f32_32x32x16_bf16 v[32:47], v[188:191], v[92:95], v[32:47]
    s_waitcnt lgkmcnt(6)
    ds_read_b128 v[188:191], v5 offset:16384
    ds_read_b64_tr_b16 v[108:109], v10 offset:22528
    ds_read_b64_tr_b16 v[110:111], v10 offset:23040
    v_mfma_f32_32x32x16_bf16 v[32:47], v[176:179], v[96:99], v[32:47]
    s_waitcnt lgkmcnt(6)
    v_mfma_f32_32x32x16_bf16 v[32:47], v[180:183], v[100:103], v[32:47]
    s_waitcnt lgkmcnt(0)
    s_barrier
    ds_read_b128 v[176:179], v2 offset:24576
    ds_read_b64_tr_b16 v[112:113], v10 offset:24576
    ds_read_b64_tr_b16 v[114:115], v10 offset:25088
    ds_read_b128 v[180:183], v3 offset:24576
    ds_read_b64_tr_b16 v[116:117], v10 offset:26624
    ds_read_b64_tr_b16 v[118:119], v10 offset:27136
    v_mfma_f32_32x32x16_bf16 v[32:47], v[184:187], v[104:107], v[32:47]
    ds_read_b128 v[184:187], v4 offset:24576
    ds_read_b64_tr_b16 v[120:121], v10 offset:28672
    ds_read_b64_tr_b16 v[122:123], v10 offset:29184
    v_mfma_f32_32x32x16_bf16 v[32:47], v[188:191], v[108:111], v[32:47]
    s_waitcnt lgkmcnt(6)
    ds_read_b128 v[188:191], v5 offset:24576
    ds_read_b64_tr_b16 v[124:125], v10 offset:30720
    ds_read_b64_tr_b16 v[126:127], v10 offset:31232
    v_mfma_f32_32x32x16_bf16 v[32:47], v[176:179], v[112:115], v[32:47]
    s_waitcnt lgkmcnt(6)
    v_mfma_f32_32x32x16_bf16 v[32:47], v[180:183], v[116:119], v[32:47]
    s_waitcnt lgkmcnt(0)
    s_barrier
    ds_read_b128 v[176:179], v2 offset:32768
    ds_read_b64_tr_b16 v[128:129], v10 offset:32768
    ds_read_b64_tr_b16 v[130:131], v10 offset:33280
    ds_read_b128 v[180:183], v3 offset:32768
    ds_read_b64_tr_b16 v[132:133], v10 offset:34816
    ds_read_b64_tr_b16 v[134:135], v10 offset:35328
    v_mfma_f32_32x32x16_bf16 v[32:47], v[184:187], v[120:123], v[32:47]
    ds_read_b128 v[184:187], v4 offset:32768
    ds_read_b64_tr_b16 v[136:137], v10 offset:36864
    ds_read_b64_tr_b16 v[138:139], v10 offset:37376
    v_mfma_f32_32x32x16_bf16 v[32:47], v[188:191], v[124:127], v[32:47]
    s_waitcnt lgkmcnt(6)
    ds_read_b128 v[188:191], v5 offset:32768
    ds_read_b64_tr_b16 v[140:141], v10 offset:38912
    ds_read_b64_tr_b16 v[142:143], v10 offset:39424
    v_mfma_f32_32x32x16_bf16 v[32:47], v[176:179], v[128:131], v[32:47]
    s_waitcnt lgkmcnt(6)
    v_mfma_f32_32x32x16_bf16 v[32:47], v[180:183], v[132:135], v[32:47]
    s_waitcnt lgkmcnt(0)
    s_barrier
    ds_read_b128 v[176:179], v2 offset:40960
    ds_read_b64_tr_b16 v[144:145], v10 offset:40960
    ds_read_b64_tr_b16 v[146:147], v10 offset:41472
    ds_read_b128 v[180:183], v3 offset:40960
    ds_read_b64_tr_b16 v[148:149], v10 offset:43008
    ds_read_b64_tr_b16 v[150:151], v10 offset:43520
    v_mfma_f32_32x32x16_bf16 v[32:47], v[184:187], v[136:139], v[32:47]
    ds_read_b128 v[184:187], v4 offset:40960
    ds_read_b64_tr_b16 v[152:153], v10 offset:45056
    ds_read_b64_tr_b16 v[154:155], v10 offset:45568
    v_mfma_f32_32x32x16_bf16 v[32:47], v[188:191], v[140:143], v[32:47]
    s_waitcnt lgkmcnt(6)
    ds_read_b128 v[188:191], v5 offset:40960
    ds_read_b64_tr_b16 v[156:157], v10 offset:47104
    ds_read_b64_tr_b16 v[158:159], v10 offset:47616
    v_mfma_f32_32x32x16_bf16 v[32:47], v[176:179], v[144:147], v[32:47]
    s_waitcnt lgkmcnt(6)
    v_mfma_f32_32x32x16_bf16 v[32:47], v[180:183], v[148:151], v[32:47]
    s_waitcnt lgkmcnt(3)
    v_mfma_f32_32x32x16_bf16 v[32:47], v[184:187], v[152:155], v[32:47]
    s_waitcnt lgkmcnt(0)
    v_mfma_f32_32x32x16_bf16 v[32:47], v[188:191], v[156:159], v[32:47]
    s_barrier
    ds_read_b128 v[176:179], v2 offset:49152
    ds_read_b64_tr_b16 v[160:161], v10 offset:49152
    ds_read_b64_tr_b16 v[162:163], v10 offset:49664
    ds_read_b128 v[180:183], v3 offset:49152
    ds_read_b64_tr_b16 v[164:165], v10 offset:51200
    ds_read_b64_tr_b16 v[166:167], v10 offset:51712
    ds_read_b128 v[184:187], v4 offset:49152
    ds_read_b64_tr_b16 v[168:169], v10 offset:53248
    ds_read_b64_tr_b16 v[170:171], v10 offset:53760
    s_waitcnt lgkmcnt(6)
    ds_read_b128 v[188:191], v5 offset:49152
    ds_read_b64_tr_b16 v[172:173], v10 offset:55296
    ds_read_b64_tr_b16 v[174:175], v10 offset:55808
    v_mfma_f32_32x32x16_bf16 v[32:47], v[176:179], v[160:163], v[32:47]
    s_waitcnt lgkmcnt(6)
    v_mfma_f32_32x32x16_bf16 v[32:47], v[180:183], v[164:167], v[32:47]
    s_waitcnt lgkmcnt(3)
    v_mfma_f32_32x32x16_bf16 v[32:47], v[184:187], v[168:171], v[32:47]
    s_waitcnt lgkmcnt(0)
    v_mfma_f32_32x32x16_bf16 v[32:47], v[188:191], v[172:175], v[32:47]
    v_add_u32 v2, 57344, v2
    v_add_u32 v3, 57344, v3
    v_add_u32 v4, 57344, v4
    v_add_u32 v5, 57344, v5
    s_nop 7
    s_add_u32 s52, s51, 17920
    s_mov_b32 exec_lo, 0xffffffff
    s_mov_b32 exec_hi, 0
    buffer_store_dwordx4 v[26:29], v19, s[40:43], s51 offen offset:512 sc1
    s_mov_b64 exec, -1
    v_cvt_pk_bf16_f32 v224, v32, v33
    v_cvt_pk_bf16_f32 v225, v34, v35
    v_cvt_pk_bf16_f32 v226, v36, v37
    v_cvt_pk_bf16_f32 v227, v38, v39
    buffer_store_dwordx4 v[224:227], v17, s[40:43], s51 offen sc1
    v_cvt_pk_bf16_f32 v228, v40, v41
    v_cvt_pk_bf16_f32 v229, v42, v43
    v_cvt_pk_bf16_f32 v230, v44, v45
    v_cvt_pk_bf16_f32 v231, v46, v47
    buffer_store_dwordx4 v[228:231], v17, s[40:43], s52 offen sc1
    s_add_u32 s51, s51, 524288
    s_mov_b32 s56, 0
    s_barrier
    ds_read_b128 v[176:179], v2 offset:0
    ds_read_b128 v[184:187], v3 offset:0
    ds_read_b128 v[192:195], v4 offset:0
    ds_read_b128 v[200:203], v5 offset:0
    ds_read_b128 v[208:211], v2 offset:8192
    s_waitcnt lgkmcnt(4)
    v_mfma_f32_32x32x16_bf16 v[32:47], v[176:179], v[64:67], 0
    ds_read_b128 v[216:219], v3 offset:8192
    s_waitcnt lgkmcnt(4)
    v_mfma_f32_32x32x16_bf16 v[32:47], v[184:187], v[68:71], v[32:47]
    ds_read_b128 v[176:179], v4 offset:8192
    s_waitcnt lgkmcnt(4)
    v_mfma_f32_32x32x16_bf16 v[32:47], v[192:195], v[72:75], v[32:47]
    ds_read_b128 v[184:187], v5 offset:8192
    s_waitcnt lgkmcnt(4)
    v_mfma_f32_32x32x16_bf16 v[32:47], v[200:203], v[76:79], v[32:47]
    s_barrier
    ds_read_b128 v[192:195], v2 offset:16384
    s_waitcnt lgkmcnt(4)
    v_mfma_f32_32x32x16_bf16 v[32:47], v[208:211], v[80:83], v[32:47]
    ds_read_b128 v[200:203], v3 offset:16384
    s_waitcnt lgkmcnt(4)
    v_mfma_f32_32x32x16_bf16 v[32:47], v[216:219], v[84:87], v[32:47]
    ds_read_b128 v[208:211], v4 offset:16384
    s_waitcnt lgkmcnt(4)
    v_mfma_f32_32x32x16_bf16 v[32:47], v[176:179], v[88:91], v[32:47]
    ds_read_b128 v[216:219], v5 offset:16384
    s_waitcnt lgkmcnt(4)
    v_mfma_f32_32x32x16_bf16 v[32:47], v[184:187], v[92:95], v[32:47]
    ds_read_b128 v[176:179], v2 offset:24576
    s_waitcnt lgkmcnt(4)
    v_mfma_f32_32x32x16_bf16 v[32:47], v[192:195], v[96:99], v[32:47]
    ds_read_b128 v[184:187], v3 offset:24576
    s_waitcnt lgkmcnt(4)
    v_mfma_f32_32x32x16_bf16 v[32:47], v[200:203], v[100:103], v[32:47]
    ds_read_b128 v[192:195], v4 offset:24576
    s_waitcnt lgkmcnt(4)
    v_mfma_f32_32x32x16_bf16 v[32:47], v[208:211], v[104:107], v[32:47]
    ds_read_b128 v[200:203], v5 offset:24576
    s_waitcnt lgkmcnt(4)
    v_mfma_f32_32x32x16_bf16 v[32:47], v[216:219], v[108:111], v[32:47]
    s_barrier
    s_waitcnt vmcnt(0)
    s_lshl_b32 s3, 1, s60
    v_mov_b32 v250, s3
    v_mov_b32 v251, 0
    v_writelane_b32 v250, 0, 4
    s_mov_b64 exec, 31
    buffer_atomic_or_x2 v[250:251], v12, s[36:39], 0 offen sc0 sc1
    s_mov_b64 exec, -1
    ds_read_b128 v[208:211], v2 offset:32768
    s_waitcnt lgkmcnt(4)
    v_mfma_f32_32x32x16_bf16 v[32:47], v[176:179], v[112:115], v[32:47]
    ds_read_b128 v[216:219], v3 offset:32768
    s_waitcnt lgkmcnt(4)
    v_mfma_f32_32x32x16_bf16 v[32:47], v[184:187], v[116:119], v[32:47]
    ds_read_b128 v[176:179], v4 offset:32768
    s_waitcnt lgkmcnt(4)
    v_mfma_f32_32x32x16_bf16 v[32:47], v[192:195], v[120:123], v[32:47]
    ds_read_b128 v[184:187], v5 offset:32768
    s_waitcnt lgkmcnt(4)
    v_mfma_f32_32x32x16_bf16 v[32:47], v[200:203], v[124:127], v[32:47]
    ds_read_b128 v[192:195], v2 offset:40960
    s_waitcnt lgkmcnt(4)
    v_mfma_f32_32x32x16_bf16 v[32:47], v[208:211], v[128:131], v[32:47]
    ds_read_b128 v[200:203], v3 offset:40960
    s_waitcnt lgkmcnt(4)
    v_mfma_f32_32x32x16_bf16 v[32:47], v[216:219], v[132:135], v[32:47]
    ds_read_b128 v[208:211], v4 offset:40960
    s_waitcnt lgkmcnt(4)
    v_mfma_f32_32x32x16_bf16 v[32:47], v[176:179], v[136:139], v[32:47]
    ds_read_b128 v[216:219], v5 offset:40960
    s_waitcnt lgkmcnt(4)
    v_mfma_f32_32x32x16_bf16 v[32:47], v[184:187], v[140:143], v[32:47]
    s_barrier
    ds_read_b128 v[176:179], v2 offset:49152
    s_waitcnt lgkmcnt(4)
    v_mfma_f32_32x32x16_bf16 v[32:47], v[192:195], v[144:147], v[32:47]
    ds_read_b128 v[184:187], v3 offset:49152
    s_waitcnt lgkmcnt(4)
    v_mfma_f32_32x32x16_bf16 v[32:47], v[200:203], v[148:151], v[32:47]
    ds_read_b128 v[192:195], v4 offset:49152
    s_waitcnt lgkmcnt(4)
    v_mfma_f32_32x32x16_bf16 v[32:47], v[208:211], v[152:155], v[32:47]
    ds_read_b128 v[200:203], v5 offset:49152
    s_waitcnt lgkmcnt(4)
    v_mfma_f32_32x32x16_bf16 v[32:47], v[216:219], v[156:159], v[32:47]
    ds_read_b128 v[208:211], v6 offset:0
    ds_read_b64_tr_b16 v[212:213], v11 offset:0
    ds_read_b64_tr_b16 v[214:215], v11 offset:256
    s_waitcnt lgkmcnt(6)
    v_mfma_f32_32x32x16_bf16 v[32:47], v[176:179], v[160:163], v[32:47]
    ds_read_b128 v[216:219], v7 offset:0
    ds_read_b64_tr_b16 v[220:221], v11 offset:1024
    ds_read_b64_tr_b16 v[222:223], v11 offset:1280
    s_waitcnt lgkmcnt(8)
    v_mfma_f32_32x32x16_bf16 v[32:47], v[184:187], v[164:167], v[32:47]
    ds_read_b128 v[176:179], v8 offset:0
    ds_read_b64_tr_b16 v[180:181], v11 offset:2048
    ds_read_b64_tr_b16 v[182:183], v11 offset:2304
    s_waitcnt lgkmcnt(10)
    v_mfma_f32_32x32x16_bf16 v[32:47], v[192:195], v[168:171], v[32:47]
    ds_read_b128 v[184:187], v9 offset:0
    ds_read_b64_tr_b16 v[188:189], v11 offset:3072
    ds_read_b64_tr_b16 v[190:191], v11 offset:3328
    s_waitcnt lgkmcnt(12)
    v_mfma_f32_32x32x16_bf16 v[32:47], v[200:203], v[172:175], v[32:47]
    ds_read_b128 v[192:195], v6 offset:8192
    ds_read_b64_tr_b16 v[196:197], v11 offset:4096
    ds_read_b64_tr_b16 v[198:199], v11 offset:4352
    s_waitcnt lgkmcnt(12)
    v_mfma_f32_32x32x16_bf16 v[48:63], v[212:215], v[208:211], 0
    ds_read_b128 v[200:203], v7 offset:8192
    ds_read_b64_tr_b16 v[204:205], v11 offset:5120
    ds_read_b64_tr_b16 v[206:207], v11 offset:5376
    s_waitcnt lgkmcnt(12)
    v_mfma_f32_32x32x16_bf16 v[48:63], v[220:223], v[216:219], v[48:63]
    ds_read_b128 v[208:211], v8 offset:8192
    ds_read_b64_tr_b16 v[212:213], v11 offset:6144
    ds_read_b64_tr_b16 v[214:215], v11 offset:6400
    s_waitcnt lgkmcnt(12)
    v_mfma_f32_32x32x16_bf16 v[48:63], v[180:183], v[176:179], v[48:63]
    ds_read_b128 v[216:219], v9 offset:8192
    ds_read_b64_tr_b16 v[220:221], v11 offset:7168
    ds_read_b64_tr_b16 v[222:223], v11 offset:7424
    s_waitcnt lgkmcnt(12)
    v_mfma_f32_32x32x16_bf16 v[48:63], v[188:191], v[184:187], v[48:63]
    s_barrier
    ds_read_b128 v[176:179], v6 offset:16384
    ds_read_b64_tr_b16 v[180:181], v11 offset:8192
    ds_read_b64_tr_b16 v[182:183], v11 offset:8448
    s_waitcnt lgkmcnt(12)
    v_mfma_f32_32x32x16_bf16 v[48:63], v[196:199], v[192:195], v[48:63]
    ds_read_b128 v[184:187], v7 offset:16384
    ds_read_b64_tr_b16 v[188:189], v11 offset:9216
    ds_read_b64_tr_b16 v[190:191], v11 offset:9472
    s_waitcnt lgkmcnt(12)
    v_mfma_f32_32x32x16_bf16 v[48:63], v[204:207], v[200:203], v[48:63]
    ds_read_b128 v[192:195], v8 offset:16384
    ds_read_b64_tr_b16 v[196:197], v11 offset:10240
    ds_read_b64_tr_b16 v[198:199], v11 offset:10496
    s_waitcnt lgkmcnt(12)
    v_mfma_f32_32x32x16_bf16 v[48:63], v[212:215], v[208:211], v[48:63]
    s_add_u32 s52, s51, 17920
    s_mov_b32 exec_lo, 0xffffffff
    s_mov_b32 exec_hi, 0
    buffer_store_dwordx4 v[26:29], v19, s[40:43], s51 offen offset:512 sc1
    s_mov_b64 exec, -1
    v_cvt_pk_bf16_f32 v232, v32, v33
    v_cvt_pk_bf16_f32 v233, v34, v35
    v_cvt_pk_bf16_f32 v234, v36, v37
    v_cvt_pk_bf16_f32 v235, v38, v39
    buffer_store_dwordx4 v[232:235], v17, s[40:43], s51 offen sc1
    v_cvt_pk_bf16_f32 v236, v40, v41
    v_cvt_pk_bf16_f32 v237, v42, v43
    v_cvt_pk_bf16_f32 v238, v44, v45
    v_cvt_pk_bf16_f32 v239, v46, v47
    buffer_store_dwordx4 v[236:239], v17, s[40:43], s52 offen sc1
    ds_read_b128 v[200:203], v9 offset:16384
    ds_read_b64_tr_b16 v[204:205], v11 offset:11264
    ds_read_b64_tr_b16 v[206:207], v11 offset:11520
    s_waitcnt lgkmcnt(12)
    v_mfma_f32_32x32x16_bf16 v[48:63], v[220:223], v[216:219], v[48:63]
    ds_read_b128 v[208:211], v6 offset:24576
    ds_read_b64_tr_b16 v[212:213], v11 offset:12288
    ds_read_b64_tr_b16 v[214:215], v11 offset:12544
    s_waitcnt lgkmcnt(12)
    v_mfma_f32_32x32x16_bf16 v[48:63], v[180:183], v[176:179], v[48:63]
    ds_read_b128 v[216:219], v7 offset:24576
    ds_read_b64_tr_b16 v[220:221], v11 offset:13312
    ds_read_b64_tr_b16 v[222:223], v11 offset:13568
    s_waitcnt lgkmcnt(12)
    v_mfma_f32_32x32x16_bf16 v[48:63], v[188:191], v[184:187], v[48:63]
    ds_read_b128 v[176:179], v8 offset:24576
    ds_read_b64_tr_b16 v[180:181], v11 offset:14336
    ds_read_b64_tr_b16 v[182:183], v11 offset:14592
    s_waitcnt lgkmcnt(12)
    v_mfma_f32_32x32x16_bf16 v[48:63], v[196:199], v[192:195], v[48:63]
    ds_read_b128 v[184:187], v9 offset:24576
    ds_read_b64_tr_b16 v[188:189], v11 offset:15360
    ds_read_b64_tr_b16 v[190:191], v11 offset:15616
    s_waitcnt lgkmcnt(12)
    v_mfma_f32_32x32x16_bf16 v[48:63], v[204:207], v[200:203], v[48:63]
    s_barrier
    ds_read_b128 v[192:195], v6 offset:32768
    ds_read_b64_tr_b16 v[196:197], v11 offset:16384
    ds_read_b64_tr_b16 v[198:199], v11 offset:16640
    s_waitcnt lgkmcnt(12)
    v_mfma_f32_32x32x16_bf16 v[48:63], v[212:215], v[208:211], v[48:63]
    ds_read_b128 v[200:203], v7 offset:32768
    ds_read_b64_tr_b16 v[204:205], v11 offset:17408
    ds_read_b64_tr_b16 v[206:207], v11 offset:17664
    s_waitcnt lgkmcnt(12)
    v_mfma_f32_32x32x16_bf16 v[48:63], v[220:223], v[216:219], v[48:63]
    ds_read_b128 v[208:211], v8 offset:32768
    ds_read_b64_tr_b16 v[212:213], v11 offset:18432
    ds_read_b64_tr_b16 v[214:215], v11 offset:18688
    s_waitcnt lgkmcnt(12)
    v_mfma_f32_32x32x16_bf16 v[48:63], v[180:183], v[176:179], v[48:63]
    ds_read_b128 v[216:219], v9 offset:32768
    ds_read_b64_tr_b16 v[220:221], v11 offset:19456
    ds_read_b64_tr_b16 v[222:223], v11 offset:19712
    s_waitcnt lgkmcnt(12)
    v_mfma_f32_32x32x16_bf16 v[48:63], v[188:191], v[184:187], v[48:63]
    ds_read_b128 v[176:179], v6 offset:40960
    ds_read_b64_tr_b16 v[180:181], v11 offset:20480
    ds_read_b64_tr_b16 v[182:183], v11 offset:20736
    s_waitcnt lgkmcnt(12)
    v_mfma_f32_32x32x16_bf16 v[48:63], v[196:199], v[192:195], v[48:63]
    ds_read_b128 v[184:187], v7 offset:40960
    ds_read_b64_tr_b16 v[188:189], v11 offset:21504
    ds_read_b64_tr_b16 v[190:191], v11 offset:21760
    s_waitcnt lgkmcnt(12)
    v_mfma_f32_32x32x16_bf16 v[48:63], v[204:207], v[200:203], v[48:63]
    ds_read_b128 v[192:195], v8 offset:40960
    ds_read_b64_tr_b16 v[196:197], v11 offset:22528
    ds_read_b64_tr_b16 v[198:199], v11 offset:22784
    s_waitcnt lgkmcnt(12)
    v_mfma_f32_32x32x16_bf16 v[48:63], v[212:215], v[208:211], v[48:63]
    ds_read_b128 v[200:203], v9 offset:40960
    ds_read_b64_tr_b16 v[204:205], v11 offset:23552
    ds_read_b64_tr_b16 v[206:207], v11 offset:23808
    s_waitcnt lgkmcnt(12)
    v_mfma_f32_32x32x16_bf16 v[48:63], v[220:223], v[216:219], v[48:63]
    s_barrier
    s_mov_b32 s59, 0x100000
    s_waitcnt vmcnt(3)
L_fc1V:
    s_mov_b64 exec, 31
    v_cmp_ne_u32 vcc, s61, v251
    s_mov_b64 exec, -1
    s_cbranch_vccnz L_fc1V_again
L_fc1V_ok:
    ds_read_b128 v[208:211], v6 offset:49152
    ds_read_b64_tr_b16 v[212:213], v11 offset:24576
    ds_read_b64_tr_b16 v[214:215], v11 offset:24832
    s_waitcnt lgkmcnt(12)
    v_mfma_f32_32x32x16_bf16 v[48:63], v[180:183], v[176:179], v[48:63]
    ds_read_b128 v[216:219], v7 offset:49152
    ds_read_b64_tr_b16 v[220:221], v11 offset:25600
    ds_read_b64_tr_b16 v[222:223], v11 offset:25856
    s_waitcnt lgkmcnt(12)
    v_mfma_f32_32x32x16_bf16 v[48:63], v[188:191], v[184:187], v[48:63]
    ds_read_b128 v[176:179], v8 offset:49152
    ds_read_b64_tr_b16 v[180:181], v11 offset:26624
    ds_read_b64_tr_b16 v[182:183], v11 offset:26880
    s_waitcnt lgkmcnt(12)
    v_mfma_f32_32x32x16_bf16 v[48:63], v[196:199], v[192:195], v[48:63]
    ds_read_b128 v[184:187], v9 offset:49152
    ds_read_b64_tr_b16 v[188:189], v11 offset:27648
    ds_read_b64_tr_b16 v[190:191], v11 offset:27904
    s_waitcnt lgkmcnt(12)
    v_mfma_f32_32x32x16_bf16 v[48:63], v[204:207], v[200:203], v[48:63]
    s_waitcnt lgkmcnt(9)
    v_mfma_f32_32x32x16_bf16 v[48:63], v[212:215], v[208:211], v[48:63]
    ds_read_b32 v15, v14
    s_waitcnt lgkmcnt(7)
    v_mfma_f32_32x32x16_bf16 v[48:63], v[220:223], v[216:219], v[48:63]
    s_waitcnt lgkmcnt(4)
    v_mfma_f32_32x32x16_bf16 v[48:63], v[180:183], v[176:179], v[48:63]
    s_waitcnt lgkmcnt(0)
    v_mfma_f32_32x32x16_bf16 v[48:63], v[188:191], v[184:187], v[48:63]
L_q:
    s_lshl_b32 s3, 0x100, s60
    v_mov_b32 v250, s3
    s_waitcnt vmcnt(0)
    s_mov_b64 exec, 15
    buffer_atomic_or v250, v12, s[36:39], 0 offen sc1
    s_mov_b64 exec, -1
    v_readfirstlane_b32 s48, v15
    s_nop 0
    s_mov_b32 s56, s48
    s_cmp_eq_u32 s56, 0
    s_cbranch_scc1 L_noearly
    s_and_b32 s50, s48, s49
    s_cbranch_scc0 L_slow0
L_back0:
    s_ff1_i32_b32 s50, s50
    s_bitset0_b32 s49, s50
    s_lshl_b32 s55, s50, 16
    buffer_load_dwordx4 v[64:67], v16, s[16:19], s55 offen offset:0 sc1
    buffer_load_dwordx4 v[68:71], v16, s[16:19], s55 offen offset:1024 sc1
    buffer_load_dwordx4 v[72:75], v24, s[16:19], s55 offen sc1
    buffer_load_dwordx4 v[76:79], v25, s[16:19], s55 offen sc1
L_noearly:
    s_mov_b32 s4, 0x3e8b97f6
    s_mov_b32 s5, s4
    v_pk_mov_b32 v[192:193], v[30:31], v[30:31]
    v_pk_mov_b32 v[194:195], v[30:31], v[30:31]
    v_pk_mov_b32 v[196:197], v[30:31], v[30:31]
    v_pk_mov_b32 v[198:199], v[30:31], v[30:31]
    v_pk_mov_b32 v[200:201], v[30:31], v[30:31]
    v_pk_mov_b32 v[208:209], v[30:31], v[30:31]
    v_pk_mov_b32 v[210:211], v[30:31], v[30:31]
    v_pk_mov_b32 v[212:213], v[30:31], v[30:31]
    v_pk_mov_b32 v[214:215], v[30:31], v[30:31]
    v_pk_mov_b32 v[216:217], v[30:31], v[30:31]
    v_pk_mul_f32 v[48:49], v[48:49], s[4:5]
    v_pk_mul_f32 v[50:51], v[50:51], s[4:5]
    v_pk_mul_f32 v[52:53], v[52:53], s[4:5]
    v_pk_mul_f32 v[54:55], v[54:55], s[4:5]
    v_pk_mul_f32 v[56:57], v[56:57], s[4:5]
    v_pk_mul_f32 v[58:59], v[58:59], s[4:5]
    v_pk_mul_f32 v[60:61], v[60:61], s[4:5]
    v_pk_mul_f32 v[62:63], v[62:63], s[4:5]
    v_cvt_pk_bf16_f32 v152, v48, v49
    v_cvt_pk_bf16_f32 v153, v50, v51
    v_cvt_pk_bf16_f32 v154, v52, v53
    v_cvt_pk_bf16_f32 v155, v54, v55
    v_cvt_pk_bf16_f32 v156, v56, v57
    v_cvt_pk_bf16_f32 v157, v58, v59
    v_cvt_pk_bf16_f32 v158, v60, v61
    v_cvt_pk_bf16_f32 v159, v62, v63
    s_bitcmp1_b32 s44, 0
    s_cselect_b32 exec_lo, -1, 0
    s_mov_b32 exec_hi, 0
    v_pk_mov_b32 v[152:153], v[30:31], v[30:31]
    s_cselect_b32 exec_hi, 0, -1
    s_mov_b32 exec_lo, 0
    v_pk_mov_b32 v[158:159], v[30:31], v[30:31]
    s_mov_b64 exec, -1
    ds_write_b128 v20, v[152:155] offset:2048
    ds_write_b128 v20, v[156:159] offset:3072
    s_cmp_lg_u32 s56, 0
    s_cbranch_scc1 L_filled
    s_and_b32 s50, s48, s49
    s_cbranch_scc0 L_slow1
L_back1:
    s_ff1_i32_b32 s50, s50
    s_bitset0_b32 s49, s50
    s_lshl_b32 s55, s50, 16
    buffer_load_dwordx4 v[64:67], v16, s[16:19], s55 offen offset:0 sc1
    buffer_load_dwordx4 v[68:71], v16, s[16:19], s55 offen offset:1024 sc1
    buffer_load_dwordx4 v[72:75], v24, s[16:19], s55 offen sc1
    buffer_load_dwordx4 v[76:79], v25, s[16:19], s55 offen sc1
L_filled:
    s_and_b32 s50, s48, s49
    s_cbranch_scc0 L_slow2
L_back2:
    s_ff1_i32_b32 s50, s50
    s_bitset0_b32 s49, s50
    s_lshl_b32 s55, s50, 16
    buffer_load_dwordx4 v[80:83], v16, s[16:19], s55 offen offset:0 sc1
    buffer_load_dwordx4 v[84:87], v16, s[16:19], s55 offen offset:1024 sc1
    buffer_load_dwordx4 v[88:91], v24, s[16:19], s55 offen sc1
    buffer_load_dwordx4 v[92:95], v25, s[16:19], s55 offen sc1
    s_waitcnt lgkmcnt(0)
    s_barrier
    ds_read_b128 v[128:131], v21 offset:2048
    ds_read_b128 v[132:135], v21 offset:3072
    ds_read_b128 v[136:139], v22 offset:2048
    ds_read_b128 v[140:143], v22 offset:3072
    ds_read_b128 v[144:147], v23 offset:2048
    ds_read_b128 v[148:151], v23 offset:3072
    v_pk_mov_b32 v[202:203], v[30:31], v[30:31]
    v_pk_mov_b32 v[204:205], v[30:31], v[30:31]
    v_pk_mov_b32 v[206:207], v[30:31], v[30:31]
    v_pk_mov_b32 v[218:219], v[30:31], v[30:31]
    v_pk_mov_b32 v[220:221], v[30:31], v[30:31]
    v_pk_mov_b32 v[222:223], v[30:31], v[30:31]
    v_pk_mov_b32 v[124:125], v[30:31], v[30:31]
    v_pk_mov_b32 v[126:127], v[30:31], v[30:31]
    v_pk_mov_b32 v[32:33], v[30:31], v[30:31]
    v_pk_mov_b32 v[34:35], v[30:31], v[30:31]
    v_pk_mov_b32 v[36:37], v[30:31], v[30:31]
    v_pk_mov_b32 v[38:39], v[30:31], v[30:31]
    s_mov_b32 s56, 3
    s_waitcnt vmcnt(4) lgkmcnt(0)
    v_mfma_f32_32x32x16_bf16 v[160:175], v[64:67], v[128:131], 0
    v_pk_mov_b32 v[40:41], v[30:31], v[30:31]
    v_pk_mov_b32 v[42:43], v[30:31], v[30:31]
    v_pk_mov_b32 v[44:45], v[30:31], v[30:31]
    v_pk_mov_b32 v[46:47], v[30:31], v[30:31]
    v_pk_mov_b32 v[48:49], v[30:31], v[30:31]
    v_pk_mov_b32 v[50:51], v[30:31], v[30:31]
    v_mfma_f32_32x32x16_bf16 v[160:175], v[68:71], v[132:135], v[160:175]
    s_and_b32 s50, s48, s49
    s_cbranch_scc0 L_slow3
L_back3:
    s_ff1_i32_b32 s50, s50
    s_bitset0_b32 s49, s50
    s_lshl_b32 s55, s50, 16
    buffer_load_dwordx4 v[96:99], v16, s[16:19], s55 offen offset:0 sc1
    buffer_load_dwordx4 v[100:103], v16, s[16:19], s55 offen offset:1024 sc1
    buffer_load_dwordx4 v[104:107], v24, s[16:19], s55 offen sc1
    buffer_load_dwordx4 v[108:111], v25, s[16:19], s55 offen sc1
    s_and_b32 s50, s48, s49
    s_cbranch_scc0 L_slow4
L_back4:
    s_ff1_i32_b32 s50, s50
    s_bitset0_b32 s49, s50
    s_lshl_b32 s55, s50, 16
    v_pk_mov_b32 v[52:53], v[30:31], v[30:31]
    v_pk_mov_b32 v[54:55], v[30:31], v[30:31]
    v_pk_mov_b32 v[56:57], v[30:31], v[30:31]
    v_pk_mov_b32 v[58:59], v[30:31], v[30:31]
    v_pk_mov_b32 v[60:61], v[30:31], v[30:31]
    v_pk_mov_b32 v[62:63], v[30:31], v[30:31]
.p2align 6
L_loop:
    v_mfma_f32_32x32x16_bf16 v[176:191], v[64:67], v[136:139], 0
    buffer_load_dwordx4 v[112:115], v16, s[16:19], s55 offen offset:0 sc1
    buffer_load_dwordx4 v[116:119], v16, s[16:19], s55 offen offset:1024 sc1
    v_exp_f32 v160, v160
    v_exp_f32 v161, v161
    v_exp_f32 v162, v162
    v_exp_f32 v163, v163
    v_cvt_pk_bf16_f32 v240, v160, v161
    v_cvt_pk_bf16_f32 v241, v162, v163
    v_mfma_f32_32x32x16_bf16 v[208:223], v[124:127], v[244:247], v[208:223]
    buffer_load_dwordx4 v[120:123], v24, s[16:19], s55 offen sc1
    buffer_load_dwordx4 v[124:127], v25, s[16:19], s55 offen sc1
    v_exp_f32 v164, v164
    v_exp_f32 v165, v165
    v_exp_f32 v166, v166
    v_exp_f32 v167, v167
    v_cvt_pk_bf16_f32 v242, v164, v165
    v_cvt_pk_bf16_f32 v243, v166, v167
    v_mfma_f32_32x32x16_bf16 v[176:191], v[68:71], v[140:143], v[176:191]
    s_and_b32 s50, s48, s49
    v_exp_f32 v168, v168
    v_exp_f32 v169, v169
    v_exp_f32 v170, v170
    v_exp_f32 v171, v171
    v_cvt_pk_bf16_f32 v244, v168, v169
    v_cvt_pk_bf16_f32 v245, v170, v171
    v_mfma_f32_32x32x16_bf16 v[32:47], v[72:75], v[240:243], v[32:47]
    s_cbranch_scc0 L_slow5
L_back5:
    v_exp_f32 v172, v172
    v_exp_f32 v173, v173
    v_exp_f32 v174, v174
    v_exp_f32 v175, v175
    v_cvt_pk_bf16_f32 v246, v172, v173
    v_cvt_pk_bf16_f32 v247, v174, v175
    v_mfma_f32_32x32x16_bf16 v[160:175], v[64:67], v[144:147], 0
    s_ff1_i32_b32 s50, s50
    v_exp_f32 v176, v176
    v_exp_f32 v177, v177
    v_exp_f32 v178, v178
    v_exp_f32 v179, v179
    v_cvt_pk_bf16_f32 v240, v176, v177
    v_cvt_pk_bf16_f32 v241, v178, v179
    v_mfma_f32_32x32x16_bf16 v[32:47], v[76:79], v[244:247], v[32:47]
    s_bitset0_b32 s49, s50
    v_exp_f32 v180, v180
    v_exp_f32 v181, v181
    v_exp_f32 v182, v182
    v_exp_f32 v183, v183
    v_cvt_pk_bf16_f32 v242, v180, v181
    v_cvt_pk_bf16_f32 v243, v182, v183
    v_mfma_f32_32x32x16_bf16 v[160:175], v[68:71], v[148:151], v[160:175]
    s_lshl_b32 s55, s50, 16
    v_exp_f32 v184, v184
    v_exp_f32 v185, v185
    v_exp_f32 v186, v186
    v_exp_f32 v187, v187
    v_cvt_pk_bf16_f32 v244, v184, v185
    v_cvt_pk_bf16_f32 v245, v186, v187
    v_mfma_f32_32x32x16_bf16 v[48:63], v[72:75], v[240:243], v[48:63]
    v_exp_f32 v188, v188
    v_exp_f32 v189, v189
    v_exp_f32 v190, v190
    v_exp_f32 v191, v191
    v_cvt_pk_bf16_f32 v246, v188, v189
    v_cvt_pk_bf16_f32 v247, v190, v191
    v_mfma_f32_32x32x16_bf16 v[176:191], v[64:67], v[152:155], 0
    v_exp_f32 v160, v160
    v_exp_f32 v161, v161
    v_exp_f32 v162, v162
    v_exp_f32 v163, v163
    v_cvt_pk_bf16_f32 v240, v160, v161
    v_cvt_pk_bf16_f32 v241, v162, v163
    v_mfma_f32_32x32x16_bf16 v[48:63], v[76:79], v[244:247], v[48:63]
    v_exp_f32 v164, v164
    v_exp_f32 v165, v165
    v_exp_f32 v166, v166
    v_exp_f32 v167, v167
    v_cvt_pk_bf16_f32 v242, v164, v165
    v_cvt_pk_bf16_f32 v243, v166, v167
    v_mfma_f32_32x32x16_bf16 v[176:191], v[68:71], v[156:159], v[176:191]
    v_exp_f32 v168, v168
    v_exp_f32 v169, v169
    v_exp_f32 v170, v170
    v_exp_f32 v171, v171
    v_cvt_pk_bf16_f32 v244, v168, v169
    v_cvt_pk_bf16_f32 v245, v170, v171
    v_mfma_f32_32x32x16_bf16 v[192:207], v[72:75], v[240:243], v[192:207]
    s_waitcnt vmcnt(8)
    v_exp_f32 v172, v172
    v_exp_f32 v173, v173
    v_exp_f32 v174, v174
    v_exp_f32 v175, v175
    v_cvt_pk_bf16_f32 v246, v172, v173
    v_cvt_pk_bf16_f32 v247, v174, v175
    v_mfma_f32_32x32x16_bf16 v[160:175], v[80:83], v[128:131], 0
    v_exp_f32 v176, v176
    v_exp_f32 v177, v177
    v_exp_f32 v178, v178
    v_exp_f32 v179, v179
    v_cvt_pk_bf16_f32 v240, v176, v177
    v_cvt_pk_bf16_f32 v241, v178, v179
    v_mfma_f32_32x32x16_bf16 v[192:207], v[76:79], v[244:247], v[192:207]
    v_exp_f32 v180, v180
    v_exp_f32 v181, v181
    v_exp_f32 v182, v182
    v_exp_f32 v183, v183
    v_cvt_pk_bf16_f32 v242, v180, v181
    v_cvt_pk_bf16_f32 v243, v182, v183
    v_mfma_f32_32x32x16_bf16 v[160:175], v[84:87], v[132:135], v[160:175]
    v_exp_f32 v184, v184
    v_exp_f32 v185, v185
    v_exp_f32 v186, v186
    v_exp_f32 v187, v187
    v_cvt_pk_bf16_f32 v244, v184, v185
    v_cvt_pk_bf16_f32 v245, v186, v187
    v_mfma_f32_32x32x16_bf16 v[208:223], v[72:75], v[240:243], v[208:223]
    v_exp_f32 v188, v188
    v_exp_f32 v189, v189
    v_exp_f32 v190, v190
    v_exp_f32 v191, v191
    v_cvt_pk_bf16_f32 v246, v188, v189
    v_cvt_pk_bf16_f32 v247, v190, v191
    v_mfma_f32_32x32x16_bf16 v[176:191], v[80:83], v[136:139], 0
    buffer_load_dwordx4 v[64:67], v16, s[16:19], s55 offen offset:0 sc1
    buffer_load_dwordx4 v[68:71], v16, s[16:19], s55 offen offset:1024 sc1
    v_exp_f32 v160, v160
    v_exp_f32 v161, v161
    v_exp_f32 v162, v162
    v_exp_f32 v163, v163
    v_cvt_pk_bf16_f32 v240, v160, v161
    v_cvt_pk_bf16_f32 v241, v162, v163
    v_mfma_f32_32x32x16_bf16 v[208:223], v[76:79], v[244:247], v[208:223]
    buffer_load_dwordx4 v[72:75], v24, s[16:19], s55 offen sc1
    buffer_load_dwordx4 v[76:79], v25, s[16:19], s55 offen sc1
    v_exp_f32 v164, v164
    v_exp_f32 v165, v165
    v_exp_f32 v166, v166
    v_exp_f32 v167, v167
    v_cvt_pk_bf16_f32 v242, v164, v165
    v_cvt_pk_bf16_f32 v243, v166, v167
    v_mfma_f32_32x32x16_bf16 v[176:191], v[84:87], v[140:143], v[176:191]
    s_and_b32 s50, s48, s49
    v_exp_f32 v168, v168
    v_exp_f32 v169, v169
    v_exp_f32 v170, v170
    v_exp_f32 v171, v171
    v_cvt_pk_bf16_f32 v244, v168, v169
    v_cvt_pk_bf16_f32 v245, v170, v171
    v_mfma_f32_32x32x16_bf16 v[32:47], v[88:91], v[240:243], v[32:47]
    s_cbranch_scc0 L_slow6
L_back6:
    v_exp_f32 v172, v172
    v_exp_f32 v173, v173
    v_exp_f32 v174, v174
    v_exp_f32 v175, v175
    v_cvt_pk_bf16_f32 v246, v172, v173
    v_cvt_pk_bf16_f32 v247, v174, v175
    v_mfma_f32_32x32x16_bf16 v[160:175], v[80:83], v[144:147], 0
    s_ff1_i32_b32 s50, s50
    v_exp_f32 v176, v176
    v_exp_f32 v177, v177
    v_exp_f32 v178, v178
    v_exp_f32 v179, v179
    v_cvt_pk_bf16_f32 v240, v176, v177
    v_cvt_pk_bf16_f32 v241, v178, v179
    v_mfma_f32_32x32x16_bf16 v[32:47], v[92:95], v[244:247], v[32:47]
    s_bitset0_b32 s49, s50
    v_exp_f32 v180, v180
    v_exp_f32 v181, v181
    v_exp_f32 v182, v182
    v_exp_f32 v183, v183
    v_cvt_pk_bf16_f32 v242, v180, v181
    v_cvt_pk_bf16_f32 v243, v182, v183
    v_mfma_f32_32x32x16_bf16 v[160:175], v[84:87], v[148:151], v[160:175]
    s_lshl_b32 s55, s50, 16
    v_exp_f32 v184, v184
    v_exp_f32 v185, v185
    v_exp_f32 v186, v186
    v_exp_f32 v187, v187
    v_cvt_pk_bf16_f32 v244, v184, v185
    v_cvt_pk_bf16_f32 v245, v186, v187
    v_mfma_f32_32x32x16_bf16 v[48:63], v[88:91], v[240:243], v[48:63]
    v_exp_f32 v188, v188
    v_exp_f32 v189, v189
    v_exp_f32 v190, v190
    v_exp_f32 v191, v191
    v_cvt_pk_bf16_f32 v246, v188, v189
    v_cvt_pk_bf16_f32 v247, v190, v191
    v_mfma_f32_32x32x16_bf16 v[176:191], v[80:83], v[152:155], 0
    v_exp_f32 v160, v160
    v_exp_f32 v161, v161
    v_exp_f32 v162, v162
    v_exp_f32 v163, v163
    v_cvt_pk_bf16_f32 v240, v160, v161
    v_cvt_pk_bf16_f32 v241, v162, v163
    v_mfma_f32_32x32x16_bf16 v[48:63], v[92:95], v[244:247], v[48:63]
    v_exp_f32 v164, v164
    v_exp_f32 v165, v165
    v_exp_f32 v166, v166
    v_exp_f32 v167, v167
    v_cvt_pk_bf16_f32 v242, v164, v165
    v_cvt_pk_bf16_f32 v243, v166, v167
    v_mfma_f32_32x32x16_bf16 v[176:191], v[84:87], v[156:159], v[176:191]
    v_exp_f32 v168, v168
    v_exp_f32 v169, v169
    v_exp_f32 v170, v170
    v_exp_f32 v171, v171
    v_cvt_pk_bf16_f32 v244, v168, v169
    v_cvt_pk_bf16_f32 v245, v170, v171
    v_mfma_f32_32x32x16_bf16 v[192:207], v[88:91], v[240:243], v[192:207]
    s_waitcnt vmcnt(8)
    v_exp_f32 v172, v172
    v_exp_f32 v173, v173
    v_exp_f32 v174, v174
    v_exp_f32 v175, v175
    v_cvt_pk_bf16_f32 v246, v172, v173
    v_cvt_pk_bf16_f32 v247, v174, v175
    v_mfma_f32_32x32x16_bf16 v[160:175], v[96:99], v[128:131], 0
    v_exp_f32 v176, v176
    v_exp_f32 v177, v177
    v_exp_f32 v178, v178
    v_exp_f32 v179, v179
    v_cvt_pk_bf16_f32 v240, v176, v177
    v_cvt_pk_bf16_f32 v241, v178, v179
    v_mfma_f32_32x32x16_bf16 v[192:207], v[92:95], v[244:247], v[192:207]
    v_exp_f32 v180, v180
    v_exp_f32 v181, v181
    v_exp_f32 v182, v182
    v_exp_f32 v183, v183
    v_cvt_pk_bf16_f32 v242, v180, v181
    v_cvt_pk_bf16_f32 v243, v182, v183
    v_mfma_f32_32x32x16_bf16 v[160:175], v[100:103], v[132:135], v[160:175]
    v_exp_f32 v184, v184
    v_exp_f32 v185, v185
    v_exp_f32 v186, v186
    v_exp_f32 v187, v187
    v_cvt_pk_bf16_f32 v244, v184, v185
    v_cvt_pk_bf16_f32 v245, v186, v187
    v_mfma_f32_32x32x16_bf16 v[208:223], v[88:91], v[240:243], v[208:223]
    v_exp_f32 v188, v188
    v_exp_f32 v189, v189
    v_exp_f32 v190, v190
    v_exp_f32 v191, v191
    v_cvt_pk_bf16_f32 v246, v188, v189
    v_cvt_pk_bf16_f32 v247, v190, v191
    v_mfma_f32_32x32x16_bf16 v[176:191], v[96:99], v[136:139], 0
    buffer_load_dwordx4 v[80:83], v16, s[16:19], s55 offen offset:0 sc1
    buffer_load_dwordx4 v[84:87], v16, s[16:19], s55 offen offset:1024 sc1
    v_exp_f32 v160, v160
    v_exp_f32 v161, v161
    v_exp_f32 v162, v162
    v_exp_f32 v163, v163
    v_cvt_pk_bf16_f32 v240, v160, v161
    v_cvt_pk_bf16_f32 v241, v162, v163
    v_mfma_f32_32x32x16_bf16 v[208:223], v[92:95], v[244:247], v[208:223]
    buffer_load_dwordx4 v[88:91], v24, s[16:19], s55 offen sc1
    buffer_load_dwordx4 v[92:95], v25, s[16:19], s55 offen sc1
    v_exp_f32 v164, v164
    v_exp_f32 v165, v165
    v_exp_f32 v166, v166
    v_exp_f32 v167, v167
    v_cvt_pk_bf16_f32 v242, v164, v165
    v_cvt_pk_bf16_f32 v243, v166, v167
    v_mfma_f32_32x32x16_bf16 v[176:191], v[100:103], v[140:143], v[176:191]
    s_and_b32 s50, s48, s49
    v_exp_f32 v168, v168
    v_exp_f32 v169, v169
    v_exp_f32 v170, v170
    v_exp_f32 v171, v171
    v_cvt_pk_bf16_f32 v244, v168, v169
    v_cvt_pk_bf16_f32 v245, v170, v171
    v_mfma_f32_32x32x16_bf16 v[32:47], v[104:107], v[240:243], v[32:47]
    s_cbranch_scc0 L_slow7
L_back7:
    v_exp_f32 v172, v172
    v_exp_f32 v173, v173
    v_exp_f32 v174, v174
    v_exp_f32 v175, v175
    v_cvt_pk_bf16_f32 v246, v172, v173
    v_cvt_pk_bf16_f32 v247, v174, v175
    v_mfma_f32_32x32x16_bf16 v[160:175], v[96:99], v[144:147], 0
    s_ff1_i32_b32 s50, s50
    v_exp_f32 v176, v176
    v_exp_f32 v177, v177
    v_exp_f32 v178, v178
    v_exp_f32 v179, v179
    v_cvt_pk_bf16_f32 v240, v176, v177
    v_cvt_pk_bf16_f32 v241, v178, v179
    v_mfma_f32_32x32x16_bf16 v[32:47], v[108:111], v[244:247], v[32:47]
    s_bitset0_b32 s49, s50
    v_exp_f32 v180, v180
    v_exp_f32 v181, v181
    v_exp_f32 v182, v182
    v_exp_f32 v183, v183
    v_cvt_pk_bf16_f32 v242, v180, v181
    v_cvt_pk_bf16_f32 v243, v182, v183
    v_mfma_f32_32x32x16_bf16 v[160:175], v[100:103], v[148:151], v[160:175]
    s_lshl_b32 s55, s50, 16
    v_exp_f32 v184, v184
    v_exp_f32 v185, v185
    v_exp_f32 v186, v186
    v_exp_f32 v187, v187
    v_cvt_pk_bf16_f32 v244, v184, v185
    v_cvt_pk_bf16_f32 v245, v186, v187
    v_mfma_f32_32x32x16_bf16 v[48:63], v[104:107], v[240:243], v[48:63]
    v_exp_f32 v188, v188
    v_exp_f32 v189, v189
    v_exp_f32 v190, v190
    v_exp_f32 v191, v191
    v_cvt_pk_bf16_f32 v246, v188, v189
    v_cvt_pk_bf16_f32 v247, v190, v191
    v_mfma_f32_32x32x16_bf16 v[176:191], v[96:99], v[152:155], 0
    v_exp_f32 v160, v160
    v_exp_f32 v161, v161
    v_exp_f32 v162, v162
    v_exp_f32 v163, v163
    v_cvt_pk_bf16_f32 v240, v160, v161
    v_cvt_pk_bf16_f32 v241, v162, v163
    v_mfma_f32_32x32x16_bf16 v[48:63], v[108:111], v[244:247], v[48:63]
    v_exp_f32 v164, v164
    v_exp_f32 v165, v165
    v_exp_f32 v166, v166
    v_exp_f32 v167, v167
    v_cvt_pk_bf16_f32 v242, v164, v165
    v_cvt_pk_bf16_f32 v243, v166, v167
    v_mfma_f32_32x32x16_bf16 v[176:191], v[100:103], v[156:159], v[176:191]
    v_exp_f32 v168, v168
    v_exp_f32 v169, v169
    v_exp_f32 v170, v170
    v_exp_f32 v171, v171
    v_cvt_pk_bf16_f32 v244, v168, v169
    v_cvt_pk_bf16_f32 v245, v170, v171
    v_mfma_f32_32x32x16_bf16 v[192:207], v[104:107], v[240:243], v[192:207]
    s_waitcnt vmcnt(8)
    v_exp_f32 v172, v172
    v_exp_f32 v173, v173
    v_exp_f32 v174, v174
    v_exp_f32 v175, v175
    v_cvt_pk_bf16_f32 v246, v172, v173
    v_cvt_pk_bf16_f32 v247, v174, v175
    v_mfma_f32_32x32x16_bf16 v[160:175], v[112:115], v[128:131], 0
    v_exp_f32 v176, v176
    v_exp_f32 v177, v177
    v_exp_f32 v178, v178
    v_exp_f32 v179, v179
    v_cvt_pk_bf16_f32 v240, v176, v177
    v_cvt_pk_bf16_f32 v241, v178, v179
    v_mfma_f32_32x32x16_bf16 v[192:207], v[108:111], v[244:247], v[192:207]
    v_exp_f32 v180, v180
    v_exp_f32 v181, v181
    v_exp_f32 v182, v182
    v_exp_f32 v183, v183
    v_cvt_pk_bf16_f32 v242, v180, v181
    v_cvt_pk_bf16_f32 v243, v182, v183
    v_mfma_f32_32x32x16_bf16 v[160:175], v[116:119], v[132:135], v[160:175]
    s_sub_u32 s56, s56, 1
    v_exp_f32 v184, v184
    v_exp_f32 v185, v185
    v_exp_f32 v186, v186
    v_exp_f32 v187, v187
    v_cvt_pk_bf16_f32 v244, v184, v185
    v_cvt_pk_bf16_f32 v245, v186, v187
    v_mfma_f32_32x32x16_bf16 v[208:223], v[104:107], v[240:243], v[208:223]
    v_exp_f32 v188, v188
    v_exp_f32 v189, v189
    v_exp_f32 v190, v190
    v_exp_f32 v191, v191
    v_cvt_pk_bf16_f32 v246, v188, v189
    v_cvt_pk_bf16_f32 v247, v190, v191
    s_cbranch_scc1 L_last
    v_mfma_f32_32x32x16_bf16 v[176:191], v[112:115], v[136:139], 0
    buffer_load_dwordx4 v[96:99], v16, s[16:19], s55 offen offset:0 sc1
    buffer_load_dwordx4 v[100:103], v16, s[16:19], s55 offen offset:1024 sc1
    v_exp_f32 v160, v160
    v_exp_f32 v161, v161
    v_exp_f32 v162, v162
    v_exp_f32 v163, v163
    v_cvt_pk_bf16_f32 v240, v160, v161
    v_cvt_pk_bf16_f32 v241, v162, v163
    v_mfma_f32_32x32x16_bf16 v[208:223], v[108:111], v[244:247], v[208:223]
    buffer_load_dwordx4 v[104:107], v24, s[16:19], s55 offen sc1
    buffer_load_dwordx4 v[108:111], v25, s[16:19], s55 offen sc1
    v_exp_f32 v164, v164
    v_exp_f32 v165, v165
    v_exp_f32 v166, v166
    v_exp_f32 v167, v167
    v_cvt_pk_bf16_f32 v242, v164, v165
    v_cvt_pk_bf16_f32 v243, v166, v167
    v_mfma_f32_32x32x16_bf16 v[176:191], v[116:119], v[140:143], v[176:191]
    s_and_b32 s50, s48, s49
    v_exp_f32 v168, v168
    v_exp_f32 v169, v169
    v_exp_f32 v170, v170
    v_exp_f32 v171, v171
    v_cvt_pk_bf16_f32 v244, v168, v169
    v_cvt_pk_bf16_f32 v245, v170, v171
    v_mfma_f32_32x32x16_bf16 v[32:47], v[120:123], v[240:243], v[32:47]
    s_cbranch_scc0 L_slow8
L_back8:
    v_exp_f32 v172, v172
    v_exp_f32 v173, v173
    v_exp_f32 v174, v174
    v_exp_f32 v175, v175
    v_cvt_pk_bf16_f32 v246, v172, v173
    v_cvt_pk_bf16_f32 v247, v174, v175
    v_mfma_f32_32x32x16_bf16 v[160:175], v[112:115], v[144:147], 0
    s_ff1_i32_b32 s50, s50
    v_exp_f32 v176, v176
    v_exp_f32 v177, v177
    v_exp_f32 v178, v178
    v_exp_f32 v179, v179
    v_cvt_pk_bf16_f32 v240, v176, v177
    v_cvt_pk_bf16_f32 v241, v178, v179
    v_mfma_f32_32x32x16_bf16 v[32:47], v[124:127], v[244:247], v[32:47]
    s_bitset0_b32 s49, s50
    v_exp_f32 v180, v180
    v_exp_f32 v181, v181
    v_exp_f32 v182, v182
    v_exp_f32 v183, v183
    v_cvt_pk_bf16_f32 v242, v180, v181
    v_cvt_pk_bf16_f32 v243, v182, v183
    v_mfma_f32_32x32x16_bf16 v[160:175], v[116:119], v[148:151], v[160:175]
    s_lshl_b32 s55, s50, 16
    v_exp_f32 v184, v184
    v_exp_f32 v185, v185
    v_exp_f32 v186, v186
    v_exp_f32 v187, v187
    v_cvt_pk_bf16_f32 v244, v184, v185
    v_cvt_pk_bf16_f32 v245, v186, v187
    v_mfma_f32_32x32x16_bf16 v[48:63], v[120:123], v[240:243], v[48:63]
    v_exp_f32 v188, v188
    v_exp_f32 v189, v189
    v_exp_f32 v190, v190
    v_exp_f32 v191, v191
    v_cvt_pk_bf16_f32 v246, v188, v189
    v_cvt_pk_bf16_f32 v247, v190, v191
    v_mfma_f32_32x32x16_bf16 v[176:191], v[112:115], v[152:155], 0
    v_exp_f32 v160, v160
    v_exp_f32 v161, v161
    v_exp_f32 v162, v162
    v_exp_f32 v163, v163
    v_cvt_pk_bf16_f32 v240, v160, v161
    v_cvt_pk_bf16_f32 v241, v162, v163
    v_mfma_f32_32x32x16_bf16 v[48:63], v[124:127], v[244:247], v[48:63]
    v_exp_f32 v164, v164
    v_exp_f32 v165, v165
    v_exp_f32 v166, v166
    v_exp_f32 v167, v167
    v_cvt_pk_bf16_f32 v242, v164, v165
    v_cvt_pk_bf16_f32 v243, v166, v167
    v_mfma_f32_32x32x16_bf16 v[176:191], v[116:119], v[156:159], v[176:191]
    v_exp_f32 v168, v168
    v_exp_f32 v169, v169
    v_exp_f32 v170, v170
    v_exp_f32 v171, v171
    v_cvt_pk_bf16_f32 v244, v168, v169
    v_cvt_pk_bf16_f32 v245, v170, v171
    v_mfma_f32_32x32x16_bf16 v[192:207], v[120:123], v[240:243], v[192:207]
    s_waitcnt vmcnt(8)
    v_exp_f32 v172, v172
    v_exp_f32 v173, v173
    v_exp_f32 v174, v174
    v_exp_f32 v175, v175
    v_cvt_pk_bf16_f32 v246, v172, v173
    v_cvt_pk_bf16_f32 v247, v174, v175
    v_mfma_f32_32x32x16_bf16 v[160:175], v[64:67], v[128:131], 0
    v_exp_f32 v176, v176
    v_exp_f32 v177, v177
    v_exp_f32 v178, v178
    v_exp_f32 v179, v179
    v_cvt_pk_bf16_f32 v240, v176, v177
    v_cvt_pk_bf16_f32 v241, v178, v179
    v_mfma_f32_32x32x16_bf16 v[192:207], v[124:127], v[244:247], v[192:207]
    v_exp_f32 v180, v180
    v_exp_f32 v181, v181
    v_exp_f32 v182, v182
    v_exp_f32 v183, v183
    v_cvt_pk_bf16_f32 v242, v180, v181
    v_cvt_pk_bf16_f32 v243, v182, v183
    v_mfma_f32_32x32x16_bf16 v[160:175], v[68:71], v[132:135], v[160:175]
    v_exp_f32 v184, v184
    v_exp_f32 v185, v185
    v_exp_f32 v186, v186
    v_exp_f32 v187, v187
    v_cvt_pk_bf16_f32 v244, v184, v185
    v_cvt_pk_bf16_f32 v245, v186, v187
    v_mfma_f32_32x32x16_bf16 v[208:223], v[120:123], v[240:243], v[208:223]
    v_exp_f32 v188, v188
    v_exp_f32 v189, v189
    v_exp_f32 v190, v190
    v_exp_f32 v191, v191
    v_cvt_pk_bf16_f32 v246, v188, v189
    v_cvt_pk_bf16_f32 v247, v190, v191
    s_branch L_loop
L_last:
    v_add_u32 v2, s8, v1
    v_add_u32 v3, s9, v1
    v_add_u32 v4, s10, v1
    v_add_u32 v5, s11, v1
    v_mfma_f32_32x32x16_bf16 v[176:191], v[112:115], v[136:139], 0
    v_exp_f32 v160, v160
    v_exp_f32 v161, v161
    v_exp_f32 v162, v162
    v_exp_f32 v163, v163
    v_cvt_pk_bf16_f32 v240, v160, v161
    v_cvt_pk_bf16_f32 v241, v162, v163
    v_mfma_f32_32x32x16_bf16 v[208:223], v[108:111], v[244:247], v[208:223]
    v_exp_f32 v164, v164
    v_exp_f32 v165, v165
    v_exp_f32 v166, v166
    v_exp_f32 v167, v167
    v_cvt_pk_bf16_f32 v242, v164, v165
    v_cvt_pk_bf16_f32 v243, v166, v167
    v_mfma_f32_32x32x16_bf16 v[176:191], v[116:119], v[140:143], v[176:191]
    v_exp_f32 v168, v168
    v_exp_f32 v169, v169
    v_exp_f32 v170, v170
    v_exp_f32 v171, v171
    v_cvt_pk_bf16_f32 v244, v168, v169
    v_cvt_pk_bf16_f32 v245, v170, v171
    v_mfma_f32_32x32x16_bf16 v[32:47], v[120:123], v[240:243], v[32:47]
    v_exp_f32 v172, v172
    v_exp_f32 v173, v173
    v_exp_f32 v174, v174
    v_exp_f32 v175, v175
    v_cvt_pk_bf16_f32 v246, v172, v173
    v_cvt_pk_bf16_f32 v247, v174, v175
    v_mfma_f32_32x32x16_bf16 v[160:175], v[112:115], v[144:147], 0
    v_exp_f32 v176, v176
    v_exp_f32 v177, v177
    v_exp_f32 v178, v178
    v_exp_f32 v179, v179
    v_cvt_pk_bf16_f32 v240, v176, v177
    v_cvt_pk_bf16_f32 v241, v178, v179
    v_mfma_f32_32x32x16_bf16 v[32:47], v[124:127], v[244:247], v[32:47]
    v_exp_f32 v180, v180
    v_exp_f32 v181, v181
    v_exp_f32 v182, v182
    v_exp_f32 v183, v183
    v_cvt_pk_bf16_f32 v242, v180, v181
    v_cvt_pk_bf16_f32 v243, v182, v183
    v_mfma_f32_32x32x16_bf16 v[160:175], v[116:119], v[148:151], v[160:175]
    v_exp_f32 v184, v184
    v_exp_f32 v185, v185
    v_exp_f32 v186, v186
    v_exp_f32 v187, v187
    v_cvt_pk_bf16_f32 v244, v184, v185
    v_cvt_pk_bf16_f32 v245, v186, v187
    v_mfma_f32_32x32x16_bf16 v[48:63], v[120:123], v[240:243], v[48:63]
    ds_write_b128 v2, v[32:35] offset:0
    v_exp_f32 v188, v188
    v_exp_f32 v189, v189
    v_exp_f32 v190, v190
    v_exp_f32 v191, v191
    v_cvt_pk_bf16_f32 v246, v188, v189
    v_cvt_pk_bf16_f32 v247, v190, v191
    v_mfma_f32_32x32x16_bf16 v[176:191], v[112:115], v[152:155], 0
    ds_write_b128 v2, v[36:39] offset:1024
    v_exp_f32 v160, v160
    v_exp_f32 v161, v161
    v_exp_f32 v162, v162
    v_exp_f32 v163, v163
    v_cvt_pk_bf16_f32 v240, v160, v161
    v_cvt_pk_bf16_f32 v241, v162, v163
    v_mfma_f32_32x32x16_bf16 v[48:63], v[124:127], v[244:247], v[48:63]
    ds_write_b128 v2, v[40:43] offset:2048
    v_exp_f32 v164, v164
    v_exp_f32 v165, v165
    v_exp_f32 v166, v166
    v_exp_f32 v167, v167
    v_cvt_pk_bf16_f32 v242, v164, v165
    v_cvt_pk_bf16_f32 v243, v166, v167
    v_mfma_f32_32x32x16_bf16 v[176:191], v[116:119], v[156:159], v[176:191]
    ds_write_b128 v2, v[44:47] offset:3072
    v_exp_f32 v168, v168
    v_exp_f32 v169, v169
    v_exp_f32 v170, v170
    v_exp_f32 v171, v171
    v_cvt_pk_bf16_f32 v244, v168, v169
    v_cvt_pk_bf16_f32 v245, v170, v171
    v_mfma_f32_32x32x16_bf16 v[192:207], v[120:123], v[240:243], v[192:207]
    ds_write_b128 v3, v[48:51] offset:0
    v_exp_f32 v172, v172
    v_exp_f32 v173, v173
    v_exp_f32 v174, v174
    v_exp_f32 v175, v175
    v_cvt_pk_bf16_f32 v246, v172, v173
    v_cvt_pk_bf16_f32 v247, v174, v175
    ds_write_b128 v3, v[52:55] offset:1024
    v_exp_f32 v176, v176
    v_exp_f32 v177, v177
    v_exp_f32 v178, v178
    v_exp_f32 v179, v179
    v_cvt_pk_bf16_f32 v240, v176, v177
    v_cvt_pk_bf16_f32 v241, v178, v179
    v_mfma_f32_32x32x16_bf16 v[192:207], v[124:127], v[244:247], v[192:207]
    ds_write_b128 v3, v[56:59] offset:2048
    v_exp_f32 v180, v180
    v_exp_f32 v181, v181
    v_exp_f32 v182, v182
    v_exp_f32 v183, v183
    v_cvt_pk_bf16_f32 v242, v180, v181
    v_cvt_pk_bf16_f32 v243, v182, v183
    ds_write_b128 v3, v[60:63] offset:3072
    v_exp_f32 v184, v184
    v_exp_f32 v185, v185
    v_exp_f32 v186, v186
    v_exp_f32 v187, v187
    v_cvt_pk_bf16_f32 v244, v184, v185
    v_cvt_pk_bf16_f32 v245, v186, v187
    v_mfma_f32_32x32x16_bf16 v[208:223], v[120:123], v[240:243], v[208:223]
    ds_write_b128 v4, v[192:195] offset:0
    v_exp_f32 v188, v188
    v_exp_f32 v189, v189
    v_exp_f32 v190, v190
    v_exp_f32 v191, v191
    v_cvt_pk_bf16_f32 v246, v188, v189
    v_cvt_pk_bf16_f32 v247, v190, v191
    ds_write_b128 v4, v[196:199] offset:1024
    ds_write_b128 v4, v[200:203] offset:2048
    v_mfma_f32_32x32x16_bf16 v[208:223], v[124:127], v[244:247], v[208:223]
    ds_write_b128 v4, v[204:207] offset:3072
    s_mov_b32 s4, 0x5e800000
    s_mov_b32 s5, 0x2b800000
    s_waitcnt vmcnt(0) lgkmcnt(0)
    s_barrier
    ds_read_b128 v[32:35], v5 offset:0
    ds_read_b128 v[36:39], v5 offset:1024
    ds_read_b128 v[40:43], v5 offset:2048
    ds_read_b128 v[44:47], v5 offset:3072
    ds_read_b128 v[48:51], v5 offset:4096
    ds_read_b128 v[52:55], v5 offset:5120
    ds_read_b128 v[56:59], v5 offset:6144
    ds_read_b128 v[60:63], v5 offset:7168
    ds_read_b128 v[192:195], v5 offset:8192
    ds_read_b128 v[196:199], v5 offset:9216
    ds_read_b128 v[200:203], v5 offset:10240
    ds_read_b128 v[204:207], v5 offset:11264
    s_lshl_b32 s3, s47, 4
    s_add_u32 s3, s3, s44
    s_lshl_b32 s3, s3, 11
    s_add_u32 s3, s3, 6291456
    s_waitcnt lgkmcnt(8)
    v_pk_add_f32 v[208:209], v[208:209], v[32:33]
    v_pk_add_f32 v[210:211], v[210:211], v[34:35]
    v_pk_add_f32 v[212:213], v[212:213], v[36:37]
    v_pk_add_f32 v[214:215], v[214:215], v[38:39]
    v_pk_add_f32 v[216:217], v[216:217], v[40:41]
    v_pk_add_f32 v[218:219], v[218:219], v[42:43]
    v_pk_add_f32 v[220:221], v[220:221], v[44:45]
    v_pk_add_f32 v[222:223], v[222:223], v[46:47]
    s_waitcnt lgkmcnt(4)
    v_pk_add_f32 v[208:209], v[208:209], v[48:49]
    v_pk_add_f32 v[210:211], v[210:211], v[50:51]
    v_pk_add_f32 v[212:213], v[212:213], v[52:53]
    v_pk_add_f32 v[214:215], v[214:215], v[54:55]
    v_pk_add_f32 v[216:217], v[216:217], v[56:57]
    v_pk_add_f32 v[218:219], v[218:219], v[58:59]
    v_pk_add_f32 v[220:221], v[220:221], v[60:61]
    v_pk_add_f32 v[222:223], v[222:223], v[62:63]
    s_waitcnt lgkmcnt(0)
    v_pk_add_f32 v[208:209], v[208:209], v[192:193]
    v_pk_add_f32 v[210:211], v[210:211], v[194:195]
    v_pk_add_f32 v[212:213], v[212:213], v[196:197]
    v_pk_add_f32 v[214:215], v[214:215], v[198:199]
    v_pk_add_f32 v[216:217], v[216:217], v[200:201]
    v_pk_add_f32 v[218:219], v[218:219], v[202:203]
    v_pk_add_f32 v[220:221], v[220:221], v[204:205]
    v_pk_add_f32 v[222:223], v[222:223], v[206:207]
    v_cmp_nge_f32 s[6:7], s4, v220
    v_cmp_nle_f32 vcc, s5, v220
    v_pk_add_f32 v[32:33], v[208:209], v[216:217]
    v_pk_add_f32 v[34:35], v[210:211], v[218:219]
    v_pk_add_f32 v[36:37], v[212:213], v[220:221]
    v_pk_add_f32 v[38:39], v[214:215], v[222:223]
    s_or_b32 s7, s7, vcc_hi
    v_pk_add_f32 v[32:33], v[32:33], v[36:37]
    v_pk_add_f32 v[34:35], v[34:35], v[38:39]
    v_pk_add_f32 v[32:33], v[32:33], v[34:35]
    v_add_f32 v32, v32, v33
    s_movk_i32 s6, 0x207
    v_cmp_class_f32 vcc, v32, s6
    s_or_b32 s7, s7, vcc_lo
    s_or_b32 s7, s7, vcc_hi
    s_cbranch_scc1 L_fallback
L_norm:
    v_mov_b32 v20, v220
    v_mov_b32 v21, v220
    s_nop 1
    v_permlane32_swap_b32 v20, v21
    s_nop 1
    v_rcp_f32 v21, v21
    s_mov_b32 exec_lo, 0
    s_mov_b32 exec_hi, 0xffffffff
    v_mov_b32 v220, 0
    s_mov_b64 exec, -1
    v_pk_mul_f32 v[208:209], v[208:209], v[20:21] op_sel:[0,1] op_sel_hi:[1,1]
    v_pk_mul_f32 v[210:211], v[210:211], v[20:21] op_sel:[0,1] op_sel_hi:[1,1]
    v_pk_mul_f32 v[212:213], v[212:213], v[20:21] op_sel:[0,1] op_sel_hi:[1,1]
    v_pk_mul_f32 v[214:215], v[214:215], v[20:21] op_sel:[0,1] op_sel_hi:[1,1]
    v_pk_mul_f32 v[216:217], v[216:217], v[20:21] op_sel:[0,1] op_sel_hi:[1,1]
    v_pk_mul_f32 v[218:219], v[218:219], v[20:21] op_sel:[0,1] op_sel_hi:[1,1]
    v_pk_mul_f32 v[220:221], v[220:221], v[20:21] op_sel:[0,1] op_sel_hi:[1,1]
    v_pk_mul_f32 v[222:223], v[222:223], v[20:21] op_sel:[0,1] op_sel_hi:[1,1]
    v_cvt_pk_bf16_f32 v232, v208, v209
    v_cvt_pk_bf16_f32 v233, v210, v211
    v_cvt_pk_bf16_f32 v234, v212, v213
    v_cvt_pk_bf16_f32 v235, v214, v215
    v_cvt_pk_bf16_f32 v236, v216, v217
    v_cvt_pk_bf16_f32 v237, v218, v219
    v_cvt_pk_bf16_f32 v238, v220, v221
    v_cvt_pk_bf16_f32 v239, v222, v223
    buffer_store_dwordx4 v[232:235], v1, s[36:39], s3 offen sc1
    buffer_store_dwordx4 v[236:239], v1, s[36:39], s3 offen offset:1024 sc1
    s_lshl_b32 s3, s46, 6
    v_bfe_u32 v20, v0, 4, 1
    v_lshlrev_b32 v20, 5, v20
    v_and_b32 v21, 3, v0
    v_lshl_add_u32 v20, v21, 3, v20
    v_add_u32 v20, s3, v20
    v_and_b32 v20, 255, v20
    v_bfe_u32 v21, v0, 2, 2
    v_lshlrev_b32 v22, 6, v21
    v_xor_b32 v20, v20, v22
    v_lshl_add_u32 v22, v21, 8, v20
    v_lshrrev_b32 v21, 5, v0
    v_lshl_add_u32 v20, v21, 10, v22
    v_add_u32 v21, 0x10000, v20
    v_add_u32 v22, 0x10000, v22
    s_lshl_b32 s3, 1, s44
    v_mov_b32 v250, s3
    ds_read_b64_tr_b16 v[64:65], v20 offset:0
    ds_read_b64_tr_b16 v[66:67], v20 offset:2048
    ds_read_b64_tr_b16 v[68:69], v20 offset:4096
    ds_read_b64_tr_b16 v[70:71], v20 offset:6144
    ds_read_b64_tr_b16 v[72:73], v20 offset:7168
    ds_read_b64_tr_b16 v[74:75], v20 offset:9216
    ds_read_b64_tr_b16 v[76:77], v20 offset:11264
    ds_read_b64_tr_b16 v[78:79], v20 offset:13312
    ds_read_b64_tr_b16 v[80:81], v20 offset:14336
    ds_read_b64_tr_b16 v[82:83], v20 offset:16384
    ds_read_b64_tr_b16 v[84:85], v20 offset:18432
    ds_read_b64_tr_b16 v[86:87], v20 offset:20480
    ds_read_b64_tr_b16 v[88:89], v20 offset:21504
    ds_read_b64_tr_b16 v[90:91], v20 offset:23552
    ds_read_b64_tr_b16 v[92:93], v20 offset:25600
    ds_read_b64_tr_b16 v[94:95], v20 offset:27648
    ds_read_b64_tr_b16 v[96:97], v20 offset:28672
    ds_read_b64_tr_b16 v[98:99], v20 offset:30720
    ds_read_b64_tr_b16 v[100:101], v20 offset:32768
    ds_read_b64_tr_b16 v[102:103], v20 offset:34816
    ds_read_b64_tr_b16 v[104:105], v20 offset:35840
    ds_read_b64_tr_b16 v[106:107], v20 offset:37888
    ds_read_b64_tr_b16 v[108:109], v20 offset:39936
    ds_read_b64_tr_b16 v[110:111], v20 offset:41984
    s_waitcnt vmcnt(0)
    s_mov_b64 exec, 1
    buffer_atomic_or v250, v13, s[36:39], 0 offen sc1
    s_mov_b64 exec, -1
    ds_read_b64_tr_b16 v[112:113], v20 offset:43008
    ds_read_b64_tr_b16 v[114:115], v20 offset:45056
    ds_read_b64_tr_b16 v[116:117], v20 offset:47104
    ds_read_b64_tr_b16 v[118:119], v20 offset:49152
    ds_read_b64_tr_b16 v[120:121], v20 offset:50176
    ds_read_b64_tr_b16 v[122:123], v20 offset:52224
    ds_read_b64_tr_b16 v[124:125], v20 offset:54272
    ds_read_b64_tr_b16 v[126:127], v20 offset:56320
    ds_read_b64_tr_b16 v[128:129], v20 offset:57344
    ds_read_b64_tr_b16 v[130:131], v20 offset:59392
    ds_read_b64_tr_b16 v[132:133], v20 offset:61440
    ds_read_b64_tr_b16 v[134:135], v20 offset:63488
    ds_read_b64_tr_b16 v[136:137], v20 offset:64512
    ds_read_b64_tr_b16 v[138:139], v21 offset:1024
    ds_read_b64_tr_b16 v[140:141], v21 offset:3072
    ds_read_b64_tr_b16 v[142:143], v21 offset:5120
    ds_read_b64_tr_b16 v[144:145], v21 offset:6144
    ds_read_b64_tr_b16 v[146:147], v21 offset:8192
    ds_read_b64_tr_b16 v[148:149], v21 offset:10240
    ds_read_b64_tr_b16 v[150:151], v21 offset:12288
    ds_read_b64_tr_b16 v[152:153], v21 offset:13312
    ds_read_b64_tr_b16 v[154:155], v21 offset:15360
    ds_read_b64_tr_b16 v[156:157], v21 offset:17408
    ds_read_b64_tr_b16 v[158:159], v21 offset:19456
    ds_read_b64_tr_b16 v[160:161], v21 offset:20480
    ds_read_b64_tr_b16 v[162:163], v21 offset:22528
    ds_read_b64_tr_b16 v[164:165], v21 offset:24576
    ds_read_b64_tr_b16 v[166:167], v21 offset:26624
    ds_read_b64_tr_b16 v[168:169], v21 offset:27648
    ds_read_b64_tr_b16 v[170:171], v21 offset:29696
    ds_read_b64_tr_b16 v[172:173], v21 offset:31744
    ds_read_b64_tr_b16 v[174:175], v21 offset:33792
    ds_read_b64_tr_b16 v[176:177], v21 offset:34816
    ds_read_b64_tr_b16 v[178:179], v21 offset:36864
    ds_read_b64_tr_b16 v[180:181], v21 offset:38912
    ds_read_b64_tr_b16 v[182:183], v21 offset:40960
    ds_read_b64_tr_b16 v[184:185], v21 offset:41984
    ds_read_b64_tr_b16 v[186:187], v21 offset:44032
    ds_read_b64_tr_b16 v[188:189], v21 offset:46080
    ds_read_b64_tr_b16 v[190:191], v22 offset:48128
    v_add_u32 v23, 114688, v1
    v_and_b32 v2, 31, v0
    v_lshrrev_b32 v3, 5, v0
    s_lshl_b32 s3, s46, 2
    v_add_u32 v3, s3, v3
    v_and_b32 v4, 15, v0
    v_xor_b32 v3, v3, v4
    v_lshlrev_b32 v2, 8, v2
    v_lshl_add_u32 v2, v3, 4, v2
    v_add_u32 v2, 147456, v2
    v_xor_b32 v3, 32, v2
    v_lshrrev_b32 v5, 4, v0
    s_lshl_b32 s3, s46, 3
    v_add_u32 v5, s3, v5
    v_mul_u32_u24 v24, 896, v5
    v_lshl_add_u32 v24, v4, 4, v24
    v_and_b32 v6, 15, v5
    v_xor_b32 v6, v6, v4
    v_lshlrev_b32 v5, 8, v5
    v_lshl_add_u32 v5, v6, 4, v5
    v_add_u32 v5, 147456, v5
    v_xor_b32 v6, 64, v5
    s_mul_i32 s55, s62, 28672
    s_lshl_b32 s3, s63, 8
    s_add_u32 s55, s55, s3
    s_cmp_eq_u32 s63, 3
    s_cselect_b32 s6, 0x00ff00ff, -1
    s_mov_b32 s7, s6
    s_barrier
    s_barrier
    s_lshl2_add_u32 s3, s63, s46
    s_cmp_ge_u32 s3, 14
    s_cbranch_scc1 L_nocols
    ds_read_b128 v[192:195], v23 offset:0
    ds_read_b128 v[196:199], v23 offset:1024
    ds_read_b128 v[200:203], v23 offset:2048
    ds_read_b128 v[204:207], v23 offset:3072
    ds_read_b128 v[208:211], v23 offset:4096
    ds_read_b128 v[212:215], v23 offset:5120
    ds_read_b128 v[216:219], v23 offset:6144
    ds_read_b128 v[220:223], v23 offset:7168
    ds_read_b128 v[224:227], v23 offset:8192
    ds_read_b128 v[228:231], v23 offset:9216
    ds_read_b128 v[232:235], v23 offset:10240
    s_waitcnt lgkmcnt(10)
    v_mfma_f32_32x32x16_bf16 v[32:47], v[64:67], v[192:195], 0
    ds_read_b128 v[236:239], v23 offset:11264
    s_waitcnt lgkmcnt(10)
    v_mfma_f32_32x32x16_bf16 v[32:47], v[68:71], v[196:199], v[32:47]
    ds_read_b128 v[192:195], v23 offset:12288
    s_waitcnt lgkmcnt(10)
    v_mfma_f32_32x32x16_bf16 v[32:47], v[72:75], v[200:203], v[32:47]
    ds_read_b128 v[196:199], v23 offset:13312
    s_waitcnt lgkmcnt(10)
    v_mfma_f32_32x32x16_bf16 v[32:47], v[76:79], v[204:207], v[32:47]
    ds_read_b128 v[200:203], v23 offset:14336
    s_waitcnt lgkmcnt(10)
    v_mfma_f32_32x32x16_bf16 v[32:47], v[80:83], v[208:211], v[32:47]
    ds_read_b128 v[204:207], v23 offset:15360
    s_waitcnt lgkmcnt(10)
    v_mfma_f32_32x32x16_bf16 v[32:47], v[84:87], v[212:215], v[32:47]
    ds_read_b128 v[208:211], v23 offset:16384
    s_waitcnt lgkmcnt(10)
    v_mfma_f32_32x32x16_bf16 v[32:47], v[88:91], v[216:219], v[32:47]
    ds_read_b128 v[212:215], v23 offset:17408
    s_waitcnt lgkmcnt(10)
    v_mfma_f32_32x32x16_bf16 v[32:47], v[92:95], v[220:223], v[32:47]
    ds_read_b128 v[216:219], v23 offset:18432
    s_waitcnt lgkmcnt(10)
    v_mfma_f32_32x32x16_bf16 v[32:47], v[96:99], v[224:227], v[32:47]
    ds_read_b128 v[220:223], v23 offset:19456
    s_waitcnt lgkmcnt(10)
    v_mfma_f32_32x32x16_bf16 v[32:47], v[100:103], v[228:231], v[32:47]
    ds_read_b128 v[224:227], v23 offset:20480
    s_waitcnt lgkmcnt(10)
    v_mfma_f32_32x32x16_bf16 v[32:47], v[104:107], v[232:235], v[32:47]
    ds_read_b128 v[228:231], v23 offset:21504
    s_waitcnt lgkmcnt(10)
    v_mfma_f32_32x32x16_bf16 v[32:47], v[108:111], v[236:239], v[32:47]
    ds_read_b128 v[232:235], v23 offset:22528
    s_waitcnt lgkmcnt(10)
    v_mfma_f32_32x32x16_bf16 v[32:47], v[112:115], v[192:195], v[32:47]
    ds_read_b128 v[236:239], v23 offset:23552
    s_waitcnt lgkmcnt(10)
    v_mfma_f32_32x32x16_bf16 v[32:47], v[116:119], v[196:199], v[32:47]
    ds_read_b128 v[192:195], v23 offset:24576
    s_waitcnt lgkmcnt(10)
    v_mfma_f32_32x32x16_bf16 v[32:47], v[120:123], v[200:203], v[32:47]
    ds_read_b128 v[196:199], v23 offset:25600
    s_waitcnt lgkmcnt(10)
    v_mfma_f32_32x32x16_bf16 v[32:47], v[124:127], v[204:207], v[32:47]
    ds_read_b128 v[200:203], v23 offset:26624
    s_waitcnt lgkmcnt(10)
    v_mfma_f32_32x32x16_bf16 v[32:47], v[128:131], v[208:211], v[32:47]
    ds_read_b128 v[204:207], v23 offset:27648
    s_waitcnt lgkmcnt(10)
    v_mfma_f32_32x32x16_bf16 v[32:47], v[132:135], v[212:215], v[32:47]
    ds_read_b128 v[208:211], v23 offset:28672
    s_waitcnt lgkmcnt(10)
    v_mfma_f32_32x32x16_bf16 v[32:47], v[136:139], v[216:219], v[32:47]
    ds_read_b128 v[212:215], v23 offset:29696
    s_waitcnt lgkmcnt(10)
    v_mfma_f32_32x32x16_bf16 v[32:47], v[140:143], v[220:223], v[32:47]
    ds_read_b128 v[216:219], v23 offset:30720
    s_waitcnt lgkmcnt(10)
    v_mfma_f32_32x32x16_bf16 v[32:47], v[144:147], v[224:227], v[32:47]
    ds_read_b128 v[220:223], v23 offset:31744
    s_waitcnt lgkmcnt(10)
    v_mfma_f32_32x32x16_bf16 v[32:47], v[148:151], v[228:231], v[32:47]
    s_waitcnt lgkmcnt(9)
    v_mfma_f32_32x32x16_bf16 v[32:47], v[152:155], v[232:235], v[32:47]
    s_waitcnt lgkmcnt(8)
    v_mfma_f32_32x32x16_bf16 v[32:47], v[156:159], v[236:239], v[32:47]
    s_waitcnt lgkmcnt(7)
    v_mfma_f32_32x32x16_bf16 v[32:47], v[160:163], v[192:195], v[32:47]
    s_waitcnt lgkmcnt(6)
    v_mfma_f32_32x32x16_bf16 v[32:47], v[164:167], v[196:199], v[32:47]
    s_waitcnt lgkmcnt(5)
    v_mfma_f32_32x32x16_bf16 v[32:47], v[168:171], v[200:203], v[32:47]
    s_waitcnt lgkmcnt(4)
    v_mfma_f32_32x32x16_bf16 v[32:47], v[172:175], v[204:207], v[32:47]
    s_waitcnt lgkmcnt(3)
    v_mfma_f32_32x32x16_bf16 v[32:47], v[176:179], v[208:211], v[32:47]
    s_waitcnt lgkmcnt(2)
    v_mfma_f32_32x32x16_bf16 v[32:47], v[180:183], v[212:215], v[32:47]
    s_waitcnt lgkmcnt(1)
    v_mfma_f32_32x32x16_bf16 v[32:47], v[184:187], v[216:219], v[32:47]
    s_waitcnt lgkmcnt(0)
    v_mfma_f32_32x32x16_bf16 v[32:47], v[188:191], v[220:223], v[32:47]
    s_nop 7
    s_nop 3
    v_cvt_pk_bf16_f32 v48, v32, v33
    v_cvt_pk_bf16_f32 v49, v34, v35
    v_cvt_pk_bf16_f32 v50, v36, v37
    v_cvt_pk_bf16_f32 v51, v38, v39
    v_cvt_pk_bf16_f32 v52, v40, v41
    v_cvt_pk_bf16_f32 v53, v42, v43
    v_cvt_pk_bf16_f32 v54, v44, v45
    v_cvt_pk_bf16_f32 v55, v46, v47
    v_permlane32_swap_b32 v48, v50
    v_permlane32_swap_b32 v49, v51
    v_permlane32_swap_b32 v52, v54
    v_permlane32_swap_b32 v53, v55
    ds_write_b128 v2, v[48:51]
    ds_write_b128 v3, v[52:55]
L_nocols:
    s_waitcnt lgkmcnt(0)
    s_barrier
    ds_read_b128 v[56:59], v5
    ds_read_b128 v[60:63], v6 offset:1024
    s_mov_b64 exec, s[6:7]
    s_waitcnt lgkmcnt(1)
    buffer_store_dwordx4 v[56:59], v24, s[28:31], s55 offen sc1
    s_waitcnt lgkmcnt(0)
    buffer_store_dwordx4 v[60:63], v24, s[28:31], s55 offen offset:3584 sc1
L_end:
    s_endpgm
L_slow0:
    ds_read_b32 v15, v14
    s_waitcnt lgkmcnt(0)
    v_readfirstlane_b32 s48, v15
    s_nop 0
    s_and_b32 s50, s48, s49
    s_cbranch_scc0 L_slow0
    s_branch L_back0
L_slow1:
    ds_read_b32 v15, v14
    s_waitcnt lgkmcnt(0)
    v_readfirstlane_b32 s48, v15
    s_nop 0
    s_and_b32 s50, s48, s49
    s_cbranch_scc0 L_slow1
    s_branch L_back1
L_slow2:
    ds_read_b32 v15, v14
    s_waitcnt lgkmcnt(0)
    v_readfirstlane_b32 s48, v15
    s_nop 0
    s_and_b32 s50, s48, s49
    s_cbranch_scc0 L_slow2
    s_branch L_back2
L_slow3:
    ds_read_b32 v15, v14
    s_waitcnt lgkmcnt(0)
    v_readfirstlane_b32 s48, v15
    s_nop 0
    s_and_b32 s50, s48, s49
    s_cbranch_scc0 L_slow3
    s_branch L_back3
L_slow4:
    ds_read_b32 v15, v14
    s_waitcnt lgkmcnt(0)
    v_readfirstlane_b32 s48, v15
    s_nop 0
    s_and_b32 s50, s48, s49
    s_cbranch_scc0 L_slow4
    s_branch L_back4
L_slow5:
    ds_read_b32 v15, v14
    s_waitcnt lgkmcnt(0)
    v_readfirstlane_b32 s48, v15
    s_nop 0
    s_and_b32 s50, s48, s49
    s_cbranch_scc0 L_slow5
    s_branch L_back5
L_slow6:
    ds_read_b32 v15, v14
    s_waitcnt lgkmcnt(0)
    v_readfirstlane_b32 s48, v15
    s_nop 0
    s_and_b32 s50, s48, s49
    s_cbranch_scc0 L_slow6
    s_branch L_back6
L_slow7:
    ds_read_b32 v15, v14
    s_waitcnt lgkmcnt(0)
    v_readfirstlane_b32 s48, v15
    s_nop 0
    s_and_b32 s50, s48, s49
    s_cbranch_scc0 L_slow7
    s_branch L_back7
L_slow8:
    ds_read_b32 v15, v14
    s_waitcnt lgkmcnt(0)
    v_readfirstlane_b32 s48, v15
    s_nop 0
    s_and_b32 s50, s48, s49
    s_cbranch_scc0 L_slow8
    s_branch L_back8
L_fc1K_again:
    s_sub_u32 s59, s59, 1
    s_cbranch_scc1 L_fc1K_ok
    s_lshl_b32 s3, 1, s60
    v_mov_b32 v250, s3
    v_mov_b32 v251, 0
    v_writelane_b32 v250, 0, 4
    s_mov_b64 exec, 31
    buffer_atomic_or_x2 v[250:251], v12, s[36:39], 0 offen sc0 sc1
    s_mov_b64 exec, -1
    s_waitcnt vmcnt(0)
    s_branch L_fc1K
L_fc1V_again:
    s_sub_u32 s59, s59, 1
    s_cbranch_scc1 L_fc1V_ok
    s_lshl_b32 s3, 1, s60
    v_mov_b32 v250, s3
    v_mov_b32 v251, 0
    v_writelane_b32 v250, 0, 4
    s_mov_b64 exec, 31
    buffer_atomic_or_x2 v[250:251], v12, s[36:39], 0 offen sc0 sc1
    s_mov_b64 exec, -1
    s_waitcnt vmcnt(0)
    s_branch L_fc1V
L_fallback:
    s_mov_b32 s16, s14
    s_and_b32 s17, s15, 0xffff
    s_mov_b32 s18, 4194304
    s_mov_b32 s19, 0x20000
    v_mov_b32 v20, 0xff800000
    s_mov_b32 s55, 0
L_fb1:
    buffer_load_dwordx4 v[64:67], v16, s[16:19], s55 offen offset:0 sc1
    buffer_load_dwordx4 v[68:71], v16, s[16:19], s55 offen offset:1024 sc1
    s_add_u32 s55, s55, 0x10000
    s_waitcnt vmcnt(0)
    v_mfma_f32_32x32x16_bf16 v[160:175], v[64:67], v[152:155], 0
    v_mfma_f32_32x32x16_bf16 v[160:175], v[68:71], v[156:159], v[160:175]
    s_nop 15
    v_max3_f32 v20, v20, v160, v161
    v_max3_f32 v20, v20, v162, v163
    v_max3_f32 v20, v20, v164, v165
    v_max3_f32 v20, v20, v166, v167
    v_max3_f32 v20, v20, v168, v169
    v_max3_f32 v20, v20, v170, v171
    v_max3_f32 v20, v20, v172, v173
    v_max3_f32 v20, v20, v174, v175
    s_cmp_lt_u32 s55, 4194304
    s_cbranch_scc1 L_fb1
    v_mov_b32 v21, v20
    s_nop 1
    v_permlane32_swap_b32 v20, v21
    s_nop 1
    v_max_f32 v20, v20, v21
    v_mov_b32 v208, 0
    v_mov_b32 v209, 0
    v_mov_b32 v210, 0
    v_mov_b32 v211, 0
    v_mov_b32 v212, 0
    v_mov_b32 v213, 0
    v_mov_b32 v214, 0
    v_mov_b32 v215, 0
    v_mov_b32 v216, 0
    v_mov_b32 v217, 0
    v_mov_b32 v218, 0
    v_mov_b32 v219, 0
    v_mov_b32 v220, 0
    v_mov_b32 v221, 0
    v_mov_b32 v222, 0
    v_mov_b32 v223, 0
    s_mov_b32 s55, 0
L_fb2:
    buffer_load_dwordx4 v[64:67], v16, s[16:19], s55 offen offset:0 sc1
    buffer_load_dwordx4 v[68:71], v16, s[16:19], s55 offen offset:1024 sc1
    buffer_load_dwordx4 v[72:75], v24, s[16:19], s55 offen sc1
    buffer_load_dwordx4 v[76:79], v25, s[16:19], s55 offen sc1
    s_add_u32 s55, s55, 0x10000
    s_waitcnt vmcnt(0)
    v_mfma_f32_32x32x16_bf16 v[160:175], v[64:67], v[152:155], 0
    v_mfma_f32_32x32x16_bf16 v[160:175], v[68:71], v[156:159], v[160:175]
    s_nop 15
    v_sub_f32 v160, v160, v20
    v_sub_f32 v161, v161, v20
    v_sub_f32 v162, v162, v20
    v_sub_f32 v163, v163, v20
    v_sub_f32 v164, v164, v20
    v_sub_f32 v165, v165, v20
    v_sub_f32 v166, v166, v20
    v_sub_f32 v167, v167, v20
    v_sub_f32 v168, v168, v20
    v_sub_f32 v169, v169, v20
    v_sub_f32 v170, v170, v20
    v_sub_f32 v171, v171, v20
    v_sub_f32 v172, v172, v20
    v_sub_f32 v173, v173, v20
    v_sub_f32 v174, v174, v20
    v_sub_f32 v175, v175, v20
    v_exp_f32 v160, v160
    v_exp_f32 v161, v161
    v_exp_f32 v162, v162
    v_exp_f32 v163, v163
    v_exp_f32 v164, v164
    v_exp_f32 v165, v165
    v_exp_f32 v166, v166
    v_exp_f32 v167, v167
    v_exp_f32 v168, v168
    v_exp_f32 v169, v169
    v_exp_f32 v170, v170
    v_exp_f32 v171, v171
    v_exp_f32 v172, v172
    v_exp_f32 v173, v173
    v_exp_f32 v174, v174
    v_exp_f32 v175, v175
    s_nop 0
    v_cvt_pk_bf16_f32 v240, v160, v161
    v_cvt_pk_bf16_f32 v241, v162, v163
    v_cvt_pk_bf16_f32 v242, v164, v165
    v_cvt_pk_bf16_f32 v243, v166, v167
    v_cvt_pk_bf16_f32 v244, v168, v169
    v_cvt_pk_bf16_f32 v245, v170, v171
    v_cvt_pk_bf16_f32 v246, v172, v173
    v_cvt_pk_bf16_f32 v247, v174, v175
    s_nop 1
    v_mfma_f32_32x32x16_bf16 v[208:223], v[72:75], v[240:243], v[208:223]
    v_mfma_f32_32x32x16_bf16 v[208:223], v[76:79], v[244:247], v[208:223]
    s_cmp_lt_u32 s55, 4194304
    s_cbranch_scc1 L_fb2
    s_nop 15
    s_branch L_norm
L_codeend:
.section .rodata,"a"
.p2align 6
.amdhsa_kernel standalone__softmax_full_mha__prompt_kernel
  .amdhsa_next_free_vgpr 256
  .amdhsa_next_free_sgpr 102
  .amdhsa_accum_offset 256
  .amdhsa_group_segment_fixed_size 0
  .amdhsa_kernarg_size 48
  .amdhsa_user_sgpr_count 2
  .amdhsa_user_sgpr_kernarg_segment_ptr 1
  .amdhsa_system_sgpr_workgroup_id_x 1
.end_amdhsa_kernel
```
